```python
import torch

def _softmax(x, axis=-1):
    return torch.softmax(x, dim=axis)
def _gelu(x):
    return torch.nn.functional.gelu(x, approximate="tanh")
def _silu(x):
    return torch.nn.functional.silu(x)
def _sigmoid(x):
    return torch.sigmoid(x)
def _layernorm(x, axis=-1, eps=1e-5):
    m = x.mean(dim=axis, keepdim=True)
    v = x.var(dim=axis, keepdim=True, unbiased=False)
    return (x - m) / torch.sqrt(v + eps)
def _scatter_add(tgt, idx, src, axis=0):
    return tgt.clone().index_add_(axis, idx, src)
def _segment_sum(src, seg, n):
    out = torch.zeros((n,) + src.shape[1:], dtype=src.dtype)
    return out.index_add_(0, seg, src)
def _pad(x, pw):
    flat = tuple(v for pair in reversed(pw) for v in pair)
    return torch.nn.functional.pad(x, flat)

kernel_name = 'gated_mix__spectral_fnet__sliding_block__prompt'

def setup_inputs():

    _w = (lambda a: (lambda t: t.to(torch.bfloat16) if t.is_floating_point() else t)(torch.as_tensor(a)))
    def _A_setup():
        B, S, D = 1, 2048, 512
        ns = torch.arange(S)[:, None] * torch.arange(S)[None, :]
        nd = torch.arange(D)[:, None] * torch.arange(D)[None, :]
        Ws_re = torch.cos(-2.0 * torch.pi * ns / S).to(float)
        Ws_im = torch.sin(-2.0 * torch.pi * ns / S).to(float)
        Wd_re = torch.cos(-2.0 * torch.pi * nd / D).to(float)
        Wd_im = torch.sin(-2.0 * torch.pi * nd / D).to(float)
        return {
            "x": _w((lambda *s: torch.randn(*s, dtype=torch.bfloat16) * 0.05)(B, S, D)),
            "dft_seq_re": _w(Ws_re),
            "dft_seq_im": _w(Ws_im),
            "dft_hid_re": _w(Wd_re),
            "dft_hid_im": _w(Wd_im),
        }
    _A_in = _A_setup()

    def _B_setup():
        B, S, D = 1, 2048, 512
        return {
            "x": _w((lambda *s: torch.randn(*s, dtype=torch.bfloat16) * 0.05)(B, S, D)),
            "wqkv": _w((lambda *s: torch.randn(*s, dtype=torch.bfloat16) * 1.6)(D, 3 * D)),
            "wo": _w((lambda *s: torch.randn(*s, dtype=torch.bfloat16) * 1.6)(D, D)),
        }
    _B_in = _B_setup()

    return {
        "A_x": _A_in["x"],
        "A_dft_seq_re": _A_in["dft_seq_re"],
        "A_dft_seq_im": _A_in["dft_seq_im"],
        "A_dft_hid_re": _A_in["dft_hid_re"],
        "A_dft_hid_im": _A_in["dft_hid_im"],
        "B_x": _B_in["x"],
        "B_wqkv": _B_in["wqkv"],
        "B_wo": _B_in["wo"],
        "gate_w": _w((lambda *s: torch.randn(*s, dtype=torch.bfloat16) * 0.05)(512) * 16.0),
    }

def reference(A_x, A_dft_seq_re, A_dft_seq_im, A_dft_hid_re, A_dft_hid_im, B_x, B_wqkv, B_wo, gate_w):
    def _A_ref(x, dft_seq_re, dft_seq_im, dft_hid_re, dft_hid_im):
        a = torch.einsum("bsd,ed->bse", x, dft_hid_re)
        b = torch.einsum("bsd,ed->bse", x, dft_hid_im)
        y = torch.einsum("ts,bse->bte", dft_seq_re, a) - torch.einsum("ts,bse->bte", dft_seq_im, b)
        return y

    def _B_ref(x, wqkv, wo):
        B, S, D = x.shape
        H = 32; Dh = D // H; W = 256
        qkv = (lambda x, *d: x.permute(*d))((x @ wqkv).reshape(B, S, 3, H, Dh), 2, 0, 3, 1, 4)
        q, k, v = qkv[0], qkv[1], qkv[2]
        scores = torch.einsum("bhqd,bhkd->bhqk", q, k) * (Dh ** -0.5)
        idx = torch.arange(S)
        mask = (idx[:, None] - idx[None, :] >= 0) & (idx[:, None] - idx[None, :] < W)
        scores = torch.where(mask[None, None], scores, -1e9)
        p = _softmax(scores, axis=-1)
        o = torch.einsum("bhqk,bhkd->bhqd", p, v)
        return (lambda x, *d: x.permute(*d))(o, 0, 2, 1, 3).reshape(B, S, D) @ wo

    x = A_x
    g = _sigmoid((x * gate_w).sum(-1, keepdims=True))
    a = _A_ref(x, A_dft_seq_re, A_dft_seq_im, A_dft_hid_re, A_dft_hid_im)
    b = _B_ref(x, B_wqkv, B_wo)
    return g * a + (1 - g) * b
```

```asm
; @launch grid=(256,1,1) block=(512,1,1) lds=163840
.amdgcn_target "amdgcn-amd-amdhsa--gfx950"
.text
.globl gated_mix__spectral_fnet__sliding_block__prompt_kernel
.p2align 8
.type gated_mix__spectral_fnet__sliding_block__prompt_kernel,@function
gated_mix__spectral_fnet__sliding_block__prompt_kernel:
  s_cmp_ge_u32 s2, 256
  s_cbranch_scc1 F_done
  s_load_dwordx2 s[4:5], s[0:1], 0
  s_load_dwordx4 s[8:11], s[0:1], 24
  s_load_dwordx2 s[12:13], s[0:1], 48
  s_load_dwordx2 s[58:59], s[0:1], 56
  s_load_dwordx2 s[6:7], s[0:1], 64
  s_load_dwordx4 s[60:63], s[0:1], 72
  s_load_dwordx2 s[14:15], s[0:1], 88
  s_getpc_b64 s[64:65]
F_pc:
  v_cmp_gt_u32 vcc, 40, v0
  s_bfe_u32 s66, s2, 0x20003
  s_mul_i32 s66, s66, 5120
  v_lshl_add_u32 v2, v0, 7, s66
  v_min_u32 v2, P2_fb-F_pc, v2
  s_and_saveexec_b64 s[66:67], vcc
  s_cbranch_execz F_nopf
  global_load_dword v19, v2, s[64:65]
F_nopf:
  s_mov_b64 exec, s[66:67]
  v_lshrrev_b32 v1, 6, v0
  v_and_b32 v0, 63, v0
  v_readfirstlane_b32 s54, v1
  v_mov_b32 v164, 0x7f000000
  s_and_b32 s40, s2, 1
  s_bfe_u32 s41, s2, 0x20001
  s_bfe_u32 s39, s2, 0x30003
  s_lshr_b32 s17, s2, 6
  s_lshl_b32 s18, s40, 3
  s_or_b32 s18, s18, s39
  s_lshl_b32 s19, s41, 2
  s_and_b32 s42, s39, 3
  s_or_b32 s20, s19, s42
  s_or_b32 s19, s19, s17
  s_lshr_b32 s3, s17, 1
  s_xor_b32 s3, s3, 1
  s_lshl_b32 s21, s40, 2
  s_bfe_u32 s43, s2, 0x20005
  s_or_b32 s21, s21, s43
  s_lshl_b32 s22, s41, 1
  s_and_b32 s23, s17, 1
  s_or_b32 s22, s22, s23
  s_and_b32 s16, s54, 3
  s_cmp_lt_u32 s54, 4
  s_cbranch_scc1 P1_compute
  v_lshrrev_b32 v2, 3, v0
  v_and_b32 v3, 7, v0
  v_lshrrev_b32 v5, 1, v2
  v_xor_b32 v6, v3, v5
  v_lshlrev_b32 v6, 4, v6
  v_xor_b32 v7, 64, v6
  s_lshl_b32 s44, s18, 17
  s_lshl_b32 s45, s16, 15
  s_add_u32 s44, s44, s45
  v_lshl_add_u32 v4, v2, 10, s44
  v_add_u32 v10, v4, v6
  v_add_u32 v11, v4, v7
  v_add_u32 v11, 0x1c00, v11
  v_add_u32 v12, 0x3800, v10
  v_add_u32 v13, 0x3800, v11
  v_and_b32 v5, 1, v5
  v_lshlrev_b32 v5, 2, v5
  v_xor_b32 v5, v3, v5
  v_lshlrev_b32 v5, 4, v5
  s_lshl_b32 s44, s16, 4
  v_add_u32 v8, s44, v2
  v_mul_u32_u24 v9, 0xc00, v8
  v_add_u32 v9, v9, v5
  s_lshl_b32 s44, s19, 7
  v_add_u32 v14, s44, v9
  v_add_u32 v15, 0x5c00, v14
  s_mul_i32 s32, s17, 1
  s_add_u32 s32, s32, s39
  s_mul_i32 s33, s41, 4
  s_add_u32 s32, s32, s33
  s_and_b32 s32, s32, 7
  s_mul_i32 s33, s32, 0x30000
  s_lshl_b32 s32, s32, 7
  s_mov_b32 s34, 0x30000
  s_lshl_b32 s35, s16, 12
  s_lshl_b32 s36, s16, 11
  s_waitcnt lgkmcnt(0)
  s_mov_b32 s24, s4
  s_mov_b32 s25, s5
  s_mov_b32 s26, 0x200000
  s_mov_b32 s27, 0x20000
  s_mov_b32 s44, s12
  s_mov_b32 s45, s13
  s_mov_b32 s46, 0x180000
  s_mov_b32 s47, 0x20000
  s_mov_b32 s37, s32
  s_mov_b32 s38, s33
  s_add_u32 m0, s35, 0x0
  s_nop 0
  buffer_load_dwordx4 v10, s[24:27], s32 offen offset:0 lds
  buffer_load_dwordx4 v11, s[24:27], s32 offen offset:1024 lds
  buffer_load_dwordx4 v12, s[24:27], s32 offen offset:2048 lds
  buffer_load_dwordx4 v13, s[24:27], s32 offen offset:3072 lds
  s_add_u32 m0, s36, 0x20000
  s_nop 0
  buffer_load_dwordx4 v14, s[44:47], s33 offen offset:0 nt lds
  buffer_load_dwordx4 v15, s[44:47], s33 offen offset:1024 nt lds
  s_add_u32 s33, s33, s34
  s_add_u32 s32, s32, 128
  s_and_b32 s32, s32, 0x3ff
  s_cselect_b32 s33, s33, 0
  s_mul_i32 s53, s42, 2
  s_mul_i32 s52, s41, 1
  s_add_u32 s53, s53, s52
  s_mul_i32 s52, s43, 2
  s_add_u32 s53, s53, s52
  s_and_b32 s53, s53, 7
  s_lshl_b32 s55, s53, 7
  s_lshl_b32 s53, s53, 16
  s_cmp_eq_u32 s40, 0
  s_cselect_b32 s48, s8, s10
  s_cselect_b32 s49, s9, s11
  s_lshl_b32 s56, s43, 7
  s_lshl_b32 s57, s22, 7
  s_add_u32 s57, s57, 0x800
  v_lshl_add_u32 v8, v8, 10, v5
  s_cmp_lg_u32 s3, 0
  s_cselect_b32 s48, s48, s12
  s_cselect_b32 s49, s49, s13
  s_mov_b32 s50, 0x180000
  s_cselect_b32 s50, 0x80000, s50
  s_mov_b32 s51, 0x20000
  s_cselect_b32 s37, s55, s37
  s_cselect_b32 s38, s53, s38
  s_mov_b32 s52, 0x30000
  s_cselect_b32 s52, 0x10000, s52
  s_cselect_b32 s56, s56, s57
  s_mov_b32 s57, 0x5c00
  s_cselect_b32 s57, 0x1c00, s57
  s_cselect_b64 vcc, -1, 0
  v_cndmask_b32 v8, v9, v8, vcc
  v_add_u32 v20, s56, v8
  v_add_u32 v21, s57, v20
  buffer_load_dwordx4 v[24:27], v20, s[48:51], s38 offen offset:0
  buffer_load_dwordx4 v[28:31], v21, s[48:51], s38 offen offset:1024
  v_lshl_add_u32 v1, v0, 4, s37
  v_and_b32 v1, 0x3ff, v1
  global_load_dwordx4 v[44:47], v1, s[6:7]
  s_lshl_b32 s56, s20, 2
  s_add_u32 s56, s56, s16
  s_lshl_b32 s56, s56, 10
  v_lshl_add_u32 v4, v2, 16, s56
  v_add_u32 v16, v4, v6
  v_add_u32 v17, v4, v7
  v_add_u32 v17, 0x7fc00, v17
  v_add_u32 v18, 0xff800, v16
  v_add_u32 v19, 0xff800, v17
  v_lshlrev_b32 v6, 4, v0
  v_lshlrev_b32 v8, 2, v0
  s_mov_b32 s28, s14
  s_mov_b32 s29, s15
  s_mov_b32 s30, 0xb00000
  s_mov_b32 s31, 0x20000
  v_lshlrev_b32 v251, 4, v0
  v_and_b32 v36, 31, v0
  v_lshrrev_b32 v37, 5, v0
  v_and_b32 v38, 0x13, v36
  v_and_b32 v39, 4, v36
  v_lshl_or_b32 v38, v39, 1, v38
  v_and_b32 v39, 8, v36
  v_lshrrev_b32 v39, 1, v39
  v_or_b32 v248, v38, v39
  v_lshlrev_b32 v38, 3, v37
  v_sub_u32 v38, v248, v38
  v_cmp_le_i32 s[64:65], 0, v38
  v_cmp_le_i32 s[66:67], 1, v38
  v_cmp_le_i32 s[68:69], 2, v38
  v_cmp_le_i32 s[70:71], 3, v38
  v_cmp_le_i32 s[72:73], 4, v38
  v_cmp_le_i32 s[74:75], 5, v38
  v_cmp_le_i32 s[76:77], 6, v38
  v_cmp_le_i32 s[78:79], 7, v38
  v_cmp_le_i32 s[80:81], 16, v38
  v_cmp_le_i32 s[82:83], 17, v38
  v_cmp_le_i32 s[84:85], 18, v38
  v_cmp_le_i32 s[86:87], 19, v38
  v_cmp_le_i32 s[88:89], 20, v38
  v_cmp_le_i32 s[90:91], 21, v38
  v_cmp_le_i32 s[92:93], 22, v38
  v_cmp_le_i32 s[94:95], 23, v38
  v_mov_b32 v39, 0xffff
  v_mov_b32 v248, 0xffff0000
  v_cndmask_b32 v232, 0, v39, s[64:65]
  v_cndmask_b32 v38, 0, v248, s[66:67]
  v_or_b32 v232, v232, v38
  v_cndmask_b32 v233, 0, v39, s[68:69]
  v_cndmask_b32 v38, 0, v248, s[70:71]
  v_or_b32 v233, v233, v38
  v_cndmask_b32 v234, 0, v39, s[72:73]
  v_cndmask_b32 v38, 0, v248, s[74:75]
  v_or_b32 v234, v234, v38
  v_cndmask_b32 v235, 0, v39, s[76:77]
  v_cndmask_b32 v38, 0, v248, s[78:79]
  v_or_b32 v235, v235, v38
  v_cndmask_b32 v236, 0, v39, s[80:81]
  v_cndmask_b32 v38, 0, v248, s[82:83]
  v_or_b32 v236, v236, v38
  v_cndmask_b32 v237, 0, v39, s[84:85]
  v_cndmask_b32 v38, 0, v248, s[86:87]
  v_or_b32 v237, v237, v38
  v_cndmask_b32 v238, 0, v39, s[88:89]
  v_cndmask_b32 v38, 0, v248, s[90:91]
  v_or_b32 v238, v238, v38
  v_cndmask_b32 v239, 0, v39, s[92:93]
  v_cndmask_b32 v38, 0, v248, s[94:95]
  v_or_b32 v239, v239, v38
  s_cmp_lt_u32 s2, 32
  s_cselect_b32 s96, 0xff800000, 0
  v_mov_b32 v216, s96
  v_mov_b32 v217, s96
  v_mov_b32 v218, s96
  v_mov_b32 v219, s96
  v_mov_b32 v220, s96
  v_mov_b32 v221, s96
  v_mov_b32 v222, s96
  v_mov_b32 v223, s96
  v_mov_b32 v224, s96
  v_mov_b32 v225, s96
  v_mov_b32 v226, s96
  v_mov_b32 v227, s96
  v_mov_b32 v228, s96
  v_mov_b32 v229, s96
  v_mov_b32 v230, s96
  v_mov_b32 v231, s96
  v_mov_b32 v249, 0xff800000
  s_lshl_b32 s96, s54, 10
  v_add_u32 v253, s96, v251
  v_and_b32 v38, 15, v0
  v_lshl_add_u32 v38, v37, 4, v38
  v_lshl_add_u32 v38, v38, 4, s96
  v_and_b32 v39, 16, v0
  v_lshl_add_u32 v254, v39, 10, v38
  s_and_b32 s98, s2, 7
  s_lshl_b32 s98, s98, 1
  s_bfe_u32 s99, s2, 0x10003
  s_or_b32 s98, s98, s99
  s_sub_u32 s99, 32, s98
  s_cmp_eq_u32 s98, 0
  s_cselect_b32 s99, 16, s99
  s_bitcmp1_b32 s2, 4
  s_cselect_b32 s96, s99, s98
  s_lshr_b32 s97, s2, 5
  s_lshr_b32 s99, s96, 2
  s_lshl_b32 s99, s99, 7
  v_lshl_add_u32 v245, v36, 10, s99
  s_and_b32 s96, s96, 3
  s_lshl_b32 s96, s96, 2
  s_and_b32 s99, s54, 1
  s_lshl_b32 s99, s99, 15
  s_add_u32 s96, s96, s99
  s_add_u32 s96, s96, 0xa00000
  v_add_u32 v245, s96, v245
  v_and_b32 v38, 4, v0
  v_lshlrev_b32 v38, 2, v38
  v_bfe_u32 v39, v0, 3, 2
  v_lshl_add_u32 v38, v39, 2, v38
  v_and_b32 v39, 3, v0
  v_add_u32 v38, v38, v39
  s_lshl_b32 s98, s98, 17
  s_add_u32 s98, s98, s99
  s_lshl_b32 s96, s97, 6
  s_bfe_u32 s99, s54, 0x10001
  s_lshl_b32 s99, s99, 5
  s_add_u32 s96, s96, s99
  v_add_u32 v38, s96, v38
  v_sub_u32 v39, 0x200, v38
  v_min_u32 v39, v38, v39
  v_and_b32 v38, 0xff, v38
  s_lshr_b32 s99, s54, 2
  s_sub_u32 s96, s99, 1
  v_cmp_eq_u32 vcc, s96, v38
  s_lshl_b32 s99, s99, 12
  s_add_u32 s98, s98, s99
  s_add_u32 s98, s98, 0x600000
  v_lshl_add_u32 v38, v37, 16, s98
  v_lshl_add_u32 v250, v39, 4, v38
  v_mov_b32 v38, 0x7f000000
  v_cndmask_b32 v250, v250, v38, vcc
  s_sub_u32 s96, 7, s97
  s_min_u32 s96, s96, s97
  s_and_b32 s98, s54, 4
  s_add_u32 s96, s96, s98
  s_lshr_b32 s98, s97, 2
  s_add_u32 s98, s98, s96
  s_min_u32 s98, s98, 7
  v_mov_b32 v38, s96
  v_mov_b32 v39, s98
  v_and_b32 v36, 8, v0
  v_cmp_eq_u32 vcc, 0, v36
  v_and_b32 v36, 3, v0
  v_lshlrev_b32 v36, 3, v36
  v_cndmask_b32 v38, v39, v38, vcc
  v_and_b32 v39, 4, v0
  v_add_u32 v36, v36, v39
  v_lshrrev_b32 v39, 2, v38
  v_add_u32 v36, v36, v39
  v_and_b32 v38, 3, v38
  v_lshl_add_u32 v36, v38, 5, v36
  s_and_b32 s96, s54, 1
  s_lshl_b32 s96, s96, 8
  s_and_b32 s98, s2, 4
  s_lshl_b32 s98, s98, 1
  s_add_u32 s96, s96, s98
  s_add_u32 s96, s96, 0xa48000
  v_lshl_add_u32 v252, v36, 7, s96
  v_lshrrev_b32 v38, 3, v0
  v_bfe_u32 v39, v0, 4, 1
  v_lshlrev_b32 v39, 2, v39
  v_and_b32 v36, 7, v0
  v_and_b32 v255, 3, v0
  v_lshlrev_b32 v255, 7, v255
  v_add_u32 v255, 0xa50200, v255
  v_xor_b32 v36, v36, v39
  v_lshlrev_b32 v36, 4, v36
  v_lshl_add_u32 v36, v38, 10, v36
  s_bfe_u32 s99, s2, 0x20003
  s_mul_i32 s99, s99, 2
  s_add_u32 s99, s99, s54
  s_and_b32 s99, s99, 7
  s_lshl_b32 s1, s99, 13
  s_add_u32 s1, s1, 0x18000
  s_lshl_b32 s99, s99, 16
  s_lshl_b32 s97, s97, 7
  s_add_u32 s99, s99, s97
  v_add_u32 v244, s99, v36
  s_mov_b32 s0, 0
  s_mov_b32 s96, s58
  s_mov_b32 s97, s59
  s_mov_b32 s98, 0x80000
  s_mov_b32 s99, 0x20000
  v_lshrrev_b32 v37, 5, v0
  s_and_b32 s6, s2, 7
  s_lshl_b32 s6, s6, 1
  s_bfe_u32 s7, s2, 0x10003
  s_or_b32 s6, s6, s7
  s_sub_u32 s7, 32, s6
  s_cmp_eq_u32 s6, 0
  s_cselect_b32 s7, 16, s7
  s_bitcmp1_b32 s2, 4
  s_cselect_b32 s4, s7, s6
  s_lshr_b32 s5, s2, 5
  v_and_b32 v36, 31, v0
  s_and_b32 s7, s54, 1
  s_lshl_b32 s7, s7, 10
  s_lshl_b32 s8, s4, 16
  s_add_u32 s8, s8, s7
  s_add_u32 s7, s7, s4
  v_lshl_add_u32 v36, v36, 5, s7
  s_and_b32 s7, s54, 6
  s_lshl_b32 s7, s7, 13
  s_add_u32 s8, s8, s7
  s_add_u32 s8, s8, 0x800000
  v_add_u32 v211, s8, v251
  v_lshlrev_b32 v38, 10, v36
  v_lshl_add_u32 v38, v37, 5, v38
  s_lshl_b32 s8, s5, 7
  s_and_b32 s7, s54, 4
  s_lshl_b32 s7, s7, 4
  s_add_u32 s8, s8, s7
  s_and_b32 s7, s54, 2
  s_lshl_b32 s7, s7, 3
  s_add_u32 s8, s8, s7
  v_add_u32 v206, s8, v38
  v_cvt_f32_u32 v36, v36
  s_cmp_gt_u32 s4, 16
  s_mov_b32 s8, 0x3a000000
  s_cselect_b32 s8, 0xba000000, s8
  s_cselect_b32 s4, 1, 0
  v_mul_f32 v36, s8, v36
  s_lshr_b32 s8, s5, 2
  s_xor_b32 s4, s4, s8
  s_cselect_b32 s4, 0x80008000, 0
  v_mov_b32 v214, s4
  v_xor_b32 v215, 0x80008000, v214
  s_and_b32 s8, s54, 6
  s_lshl_b32 s8, s8, 2
  s_cmp_ge_u32 s6, 8
  s_cselect_b32 s4, 2, 0
  s_cselect_b32 s6, 0xc0400000, 1.0
  s_cselect_b32 s7, 0x40a00000, 1.0
  s_add_u32 s8, s8, s4
  v_lshl_add_u32 v38, v37, 5, s8
  v_cvt_f32_u32 v38, v38
  v_mul_f32 v38, v38, v36
  v_fract_f32 v38, v38
  v_cos_f32 v188, v38
  v_sin_f32 v190, v38
  v_add_f32 v38, v38, v36
  v_cos_f32 v189, v38
  v_sin_f32 v191, v38
  v_fma_f32 v38, v36, s6, v38
  v_cos_f32 v192, v38
  v_sin_f32 v194, v38
  v_add_f32 v38, v38, v36
  v_cos_f32 v193, v38
  v_sin_f32 v195, v38
  v_fma_f32 v38, v36, s7, v38
  v_cos_f32 v196, v38
  v_sin_f32 v198, v38
  v_add_f32 v38, v38, v36
  v_cos_f32 v197, v38
  v_sin_f32 v199, v38
  v_fma_f32 v38, v36, s6, v38
  v_cos_f32 v200, v38
  v_sin_f32 v202, v38
  v_add_f32 v38, v38, v36
  v_cos_f32 v201, v38
  v_sin_f32 v203, v38
  v_fma_f32 v38, v36, s7, v38
  s_and_b32 s8, s54, 2
  s_lshl_b32 s8, s8, 7
  v_xor_b32 v38, s8, v251
  s_and_b32 s8, s54, 6
  s_lshl_b32 s8, s8, 10
  s_and_b32 s4, s54, 4
  s_lshl_b32 s4, s4, 11
  s_add_u32 s8, s8, s4
  s_add_u32 s8, s8, 0x10000
  v_add_u32 v204, s8, v38
  v_bfe_u32 v38, v0, 2, 2
  v_lshl_add_u32 v39, v37, 3, v38
  v_lshlrev_b32 v39, 7, v39
  v_lshrrev_b32 v38, 1, v38
  s_lshr_b32 s8, s54, 2
  v_xor_b32 v38, s8, v38
  v_lshl_add_u32 v39, v38, 6, v39
  v_and_b32 v38, 1, v0
  v_lshl_add_u32 v39, v38, 5, v39
  s_and_b32 s8, s54, 2
  s_lshl_b32 s8, s8, 3
  v_and_b32 v38, 16, v0
  v_xor_b32 v38, s8, v38
  v_add_u32 v39, v38, v39
  v_and_b32 v38, 2, v0
  v_lshl_add_u32 v39, v38, 2, v39
  s_and_b32 s8, s54, 6
  s_lshl_b32 s8, s8, 13
  s_mul_i32 s4, s5, 2048
  s_add_u32 s8, s8, s4
  s_add_u32 s8, s8, 0x18000
  v_add_u32 v205, s8, v39
  s_lshl_b32 s8, s54, 11
  v_add_u32 v207, s8, v251
  v_xor_b32 v208, 0x1000, v207
  v_xor_b32 v209, 0x2000, v207
  v_xor_b32 v210, 0x3000, v207
  v_and_b32 v36, 7, v0
  v_xor_b32 v38, s54, v36
  v_lshlrev_b32 v38, 4, v38
  v_lshl_add_u32 v212, v0, 7, v38
  v_lshrrev_b32 v38, 3, v0
  v_xor_b32 v36, v36, v38
  s_and_b32 s8, s54, 3
  s_lshl_b32 s8, s8, 3
  v_add_u32 v38, s8, v38
  v_and_b32 v39, 0x13, v38
  v_and_b32 v37, 4, v38
  v_lshl_or_b32 v39, v37, 1, v39
  v_and_b32 v37, 8, v38
  v_lshrrev_b32 v37, 1, v37
  v_or_b32 v38, v39, v37
  v_lshlrev_b32 v36, 4, v36
  v_lshl_add_u32 v36, v38, 16, v36
  s_and_b32 s8, s2, 7
  s_lshl_b32 s8, s8, 13
  s_bfe_u32 s4, s2, 0x20003
  s_lshl_b32 s4, s4, 11
  s_add_u32 s8, s8, s4
  s_lshr_b32 s4, s2, 7
  s_lshl_b32 s4, s4, 10
  s_add_u32 s8, s8, s4
  s_lshr_b32 s4, s54, 2
  s_lshl_b32 s4, s4, 9
  s_add_u32 s8, s8, s4
  s_bfe_u32 s4, s2, 0x20005
  s_lshl_b32 s4, s4, 7
  s_add_u32 s8, s8, s4
  s_add_u32 s8, s8, 0x800000
  v_add_u32 v213, s8, v36
  s_add_u32 m0, s35, 0x4000
  s_nop 0
  buffer_load_dwordx4 v10, s[24:27], s32 offen offset:0 lds
  buffer_load_dwordx4 v11, s[24:27], s32 offen offset:1024 lds
  buffer_load_dwordx4 v12, s[24:27], s32 offen offset:2048 lds
  buffer_load_dwordx4 v13, s[24:27], s32 offen offset:3072 lds
  s_add_u32 m0, s36, 0x22000
  s_nop 0
  buffer_load_dwordx4 v14, s[44:47], s33 offen offset:0  lds
  buffer_load_dwordx4 v15, s[44:47], s33 offen offset:1024  lds
  s_add_u32 s33, s33, s34
  s_add_u32 s32, s32, 128
  s_and_b32 s32, s32, 0x3ff
  s_cselect_b32 s33, s33, 0
  s_waitcnt vmcnt(9)
  s_barrier
  s_add_u32 m0, s35, 0x8000
  s_nop 0
  buffer_load_dwordx4 v10, s[24:27], s32 offen offset:0 lds
  buffer_load_dwordx4 v11, s[24:27], s32 offen offset:1024 lds
  buffer_load_dwordx4 v12, s[24:27], s32 offen offset:2048 lds
  buffer_load_dwordx4 v13, s[24:27], s32 offen offset:3072 lds
  s_add_u32 m0, s36, 0x24000
  s_nop 0
  buffer_load_dwordx4 v14, s[44:47], s33 offen offset:0  lds
  buffer_load_dwordx4 v15, s[44:47], s33 offen offset:1024  lds
  s_add_u32 s33, s33, s34
  s_add_u32 s32, s32, 128
  s_and_b32 s32, s32, 0x3ff
  s_cselect_b32 s33, s33, 0
  s_add_u32 m0, s35, 0xc000
  s_nop 0
  buffer_load_dwordx4 v10, s[24:27], s32 offen offset:0 lds
  buffer_load_dwordx4 v11, s[24:27], s32 offen offset:1024 lds
  buffer_load_dwordx4 v12, s[24:27], s32 offen offset:2048 lds
  buffer_load_dwordx4 v13, s[24:27], s32 offen offset:3072 lds
  s_add_u32 m0, s36, 0x26000
  s_nop 0
  buffer_load_dwordx4 v14, s[44:47], s33 offen offset:0  lds
  buffer_load_dwordx4 v15, s[44:47], s33 offen offset:1024  lds
  s_add_u32 s33, s33, s34
  s_add_u32 s32, s32, 128
  s_and_b32 s32, s32, 0x3ff
  s_cselect_b32 s33, s33, 0
  s_waitcnt vmcnt(12)
  s_barrier
  s_add_u32 m0, s35, 0x10000
  s_nop 0
  buffer_load_dwordx4 v10, s[24:27], s32 offen offset:0 lds
  buffer_load_dwordx4 v11, s[24:27], s32 offen offset:1024 lds
  buffer_load_dwordx4 v12, s[24:27], s32 offen offset:2048 lds
  buffer_load_dwordx4 v13, s[24:27], s32 offen offset:3072 lds
  s_add_u32 m0, s36, 0x20000
  s_nop 0
  buffer_load_dwordx4 v14, s[44:47], s33 offen offset:0  lds
  buffer_load_dwordx4 v15, s[44:47], s33 offen offset:1024  lds
  s_add_u32 s33, s33, s34
  s_add_u32 s32, s32, 128
  s_and_b32 s32, s32, 0x3ff
  s_cselect_b32 s33, s33, 0
  s_waitcnt vmcnt(12)
  s_barrier
  s_add_u32 m0, s35, 0x14000
  s_nop 0
  buffer_load_dwordx4 v10, s[24:27], s32 offen offset:0 lds
  buffer_load_dwordx4 v11, s[24:27], s32 offen offset:1024 lds
  buffer_load_dwordx4 v12, s[24:27], s32 offen offset:2048 lds
  buffer_load_dwordx4 v13, s[24:27], s32 offen offset:3072 lds
  s_add_u32 m0, s36, 0x22000
  s_nop 0
  buffer_load_dwordx4 v14, s[44:47], s33 offen offset:0  lds
  buffer_load_dwordx4 v15, s[44:47], s33 offen offset:1024  lds
  s_add_u32 s33, s33, s34
  s_add_u32 s32, s32, 128
  s_and_b32 s32, s32, 0x3ff
  s_cselect_b32 s33, s33, 0
  s_waitcnt vmcnt(12)
  s_barrier
  s_add_u32 m0, s35, 0x18000
  s_nop 0
  buffer_load_dwordx4 v10, s[24:27], s32 offen offset:0 lds
  buffer_load_dwordx4 v11, s[24:27], s32 offen offset:1024 lds
  buffer_load_dwordx4 v12, s[24:27], s32 offen offset:2048 lds
  buffer_load_dwordx4 v13, s[24:27], s32 offen offset:3072 lds
  s_add_u32 m0, s36, 0x24000
  s_nop 0
  buffer_load_dwordx4 v14, s[44:47], s33 offen offset:0  lds
  buffer_load_dwordx4 v15, s[44:47], s33 offen offset:1024  lds
  s_add_u32 s33, s33, s34
  s_add_u32 s32, s32, 128
  s_and_b32 s32, s32, 0x3ff
  s_cselect_b32 s33, s33, 0
  s_waitcnt vmcnt(12)
  s_barrier
  s_add_u32 m0, s35, 0x1c000
  s_nop 0
  buffer_load_dwordx4 v10, s[24:27], s32 offen offset:0 lds
  buffer_load_dwordx4 v11, s[24:27], s32 offen offset:1024 lds
  buffer_load_dwordx4 v12, s[24:27], s32 offen offset:2048 lds
  buffer_load_dwordx4 v13, s[24:27], s32 offen offset:3072 lds
  s_add_u32 m0, s36, 0x26000
  s_nop 0
  buffer_load_dwordx4 v14, s[44:47], s33 offen offset:0  lds
  buffer_load_dwordx4 v15, s[44:47], s33 offen offset:1024  lds
  s_mov_b32 s32, s37
  s_mov_b32 s33, s38
  s_mov_b32 s34, s52
  s_cmp_lg_u32 s3, 0
  s_cbranch_scc1 P1_LA
  s_waitcnt vmcnt(12)
  s_barrier
  s_add_u32 m0, s36, 0x20000
  s_nop 0
  buffer_load_dwordx4 v20, s[48:51], s33 offen offset:0  lds
  buffer_load_dwordx4 v21, s[48:51], s33 offen offset:1024  lds
  s_add_u32 s33, s33, s34
  s_add_u32 s32, s32, 128
  s_and_b32 s32, s32, 0x3ff
  s_cselect_b32 s33, s33, 0
  s_waitcnt vmcnt(8)
  s_barrier
  s_add_u32 m0, s36, 0x22000
  s_nop 0
  buffer_load_dwordx4 v20, s[48:51], s33 offen offset:0  lds
  buffer_load_dwordx4 v21, s[48:51], s33 offen offset:1024  lds
  s_add_u32 s33, s33, s34
  s_add_u32 s32, s32, 128
  s_and_b32 s32, s32, 0x3ff
  s_cselect_b32 s33, s33, 0
  s_waitcnt vmcnt(4)
  s_barrier
  s_add_u32 m0, s36, 0x24000
  s_nop 0
  buffer_load_dwordx4 v20, s[48:51], s33 offen offset:0  lds
  buffer_load_dwordx4 v21, s[48:51], s33 offen offset:1024  lds
  s_add_u32 s33, s33, s34
  s_add_u32 s32, s32, 128
  s_and_b32 s32, s32, 0x3ff
  s_cselect_b32 s33, s33, 0
  s_waitcnt vmcnt(4)
  s_barrier
  s_add_u32 m0, s36, 0x26000
  s_nop 0
  buffer_load_dwordx4 v20, s[48:51], s33 offen offset:0  lds
  buffer_load_dwordx4 v21, s[48:51], s33 offen offset:1024  lds
  s_add_u32 s33, s33, s34
  s_add_u32 s32, s32, 128
  s_and_b32 s32, s32, 0x3ff
  s_cselect_b32 s33, s33, 0
  s_load_dword s4, s[62:63], 0
  s_lshl_b32 s56, s22, 4
  s_lshl_b32 s57, s16, 2
  s_add_u32 s56, s56, s57
  s_lshr_b32 s57, s56, 1
  s_and_b32 s57, s57, 7
  v_xor_b32 v1, s57, v3
  v_lshlrev_b32 v1, 4, v1
  v_lshl_add_u32 v1, v2, 14, v1
  s_lshl_b32 s57, s56, 7
  v_add_u32 v1, s57, v1
  v_xor_b32 v4, 16, v1
  ds_read_b128 v[48:51], v1 offset:0
  ds_read_b128 v[52:55], v1 offset:128
  ds_read_b128 v[56:59], v4 offset:256
  ds_read_b128 v[60:63], v4 offset:384
  v_mov_b32 v64, 0
  v_mov_b32 v65, 0
  v_mov_b32 v66, 0
  v_mov_b32 v67, 0
  s_waitcnt lgkmcnt(0)
  v_dot2c_f32_bf16 v64, v48, v44
  v_dot2c_f32_bf16 v65, v52, v44
  v_dot2c_f32_bf16 v66, v56, v44
  v_dot2c_f32_bf16 v67, v60, v44
  v_dot2c_f32_bf16 v64, v49, v45
  v_dot2c_f32_bf16 v65, v53, v45
  v_dot2c_f32_bf16 v66, v57, v45
  v_dot2c_f32_bf16 v67, v61, v45
  v_dot2c_f32_bf16 v64, v50, v46
  v_dot2c_f32_bf16 v65, v54, v46
  v_dot2c_f32_bf16 v66, v58, v46
  v_dot2c_f32_bf16 v67, v62, v46
  v_dot2c_f32_bf16 v64, v51, v47
  v_dot2c_f32_bf16 v65, v55, v47
  v_dot2c_f32_bf16 v66, v59, v47
  v_dot2c_f32_bf16 v67, v63, v47
  v_add_f32_dpp v64, v64, v64 row_shr:1 row_mask:0xf bank_mask:0xf bound_ctrl:0
  v_add_f32_dpp v65, v65, v65 row_shr:1 row_mask:0xf bank_mask:0xf bound_ctrl:0
  v_add_f32_dpp v66, v66, v66 row_shr:1 row_mask:0xf bank_mask:0xf bound_ctrl:0
  v_add_f32_dpp v67, v67, v67 row_shr:1 row_mask:0xf bank_mask:0xf bound_ctrl:0
  v_add_f32_dpp v64, v64, v64 row_shr:2 row_mask:0xf bank_mask:0xf bound_ctrl:0
  v_add_f32_dpp v65, v65, v65 row_shr:2 row_mask:0xf bank_mask:0xf bound_ctrl:0
  v_add_f32_dpp v66, v66, v66 row_shr:2 row_mask:0xf bank_mask:0xf bound_ctrl:0
  v_add_f32_dpp v67, v67, v67 row_shr:2 row_mask:0xf bank_mask:0xf bound_ctrl:0
  v_add_f32_dpp v64, v64, v64 row_shr:4 row_mask:0xf bank_mask:0xf bound_ctrl:0
  v_add_f32_dpp v65, v65, v65 row_shr:4 row_mask:0xf bank_mask:0xf bound_ctrl:0
  v_add_f32_dpp v66, v66, v66 row_shr:4 row_mask:0xf bank_mask:0xf bound_ctrl:0
  v_add_f32_dpp v67, v67, v67 row_shr:4 row_mask:0xf bank_mask:0xf bound_ctrl:0
  v_add_f32_dpp v64, v64, v64 row_shr:8 row_mask:0xf bank_mask:0xf bound_ctrl:0
  v_add_f32_dpp v65, v65, v65 row_shr:8 row_mask:0xf bank_mask:0xf bound_ctrl:0
  v_add_f32_dpp v66, v66, v66 row_shr:8 row_mask:0xf bank_mask:0xf bound_ctrl:0
  v_add_f32_dpp v67, v67, v67 row_shr:8 row_mask:0xf bank_mask:0xf bound_ctrl:0
  v_add_f32_dpp v64, v64, v64 row_bcast:15 row_mask:0xa bank_mask:0xf
  v_add_f32_dpp v65, v65, v65 row_bcast:15 row_mask:0xa bank_mask:0xf
  v_add_f32_dpp v66, v66, v66 row_bcast:15 row_mask:0xa bank_mask:0xf
  v_add_f32_dpp v67, v67, v67 row_bcast:15 row_mask:0xa bank_mask:0xf
  v_add_f32_dpp v64, v64, v64 row_bcast:31 row_mask:0xc bank_mask:0xf
  v_add_f32_dpp v65, v65, v65 row_bcast:31 row_mask:0xc bank_mask:0xf
  v_add_f32_dpp v66, v66, v66 row_bcast:31 row_mask:0xc bank_mask:0xf
  v_add_f32_dpp v67, v67, v67 row_bcast:31 row_mask:0xc bank_mask:0xf
  v_min_f32 v64, 0x41f00000, v64
  v_min_f32 v65, 0x41f00000, v65
  v_min_f32 v66, 0x41f00000, v66
  v_min_f32 v67, 0x41f00000, v67
  v_mul_f32 v64, 0x3fb8aa3b, v64
  v_mul_f32 v65, 0x3fb8aa3b, v65
  v_mul_f32 v66, 0x3fb8aa3b, v66
  v_mul_f32 v67, 0x3fb8aa3b, v67
  v_exp_f32 v64, v64
  v_exp_f32 v65, v65
  v_exp_f32 v66, v66
  v_exp_f32 v67, v67
  v_readlane_b32 s40, v64, 63
  v_readlane_b32 s41, v65, 63
  v_readlane_b32 s42, v66, 63
  v_readlane_b32 s43, v67, 63
  s_lshl_b32 s57, s18, 7
  s_add_u32 s56, s56, s57
  s_lshl_b32 s56, s56, 5
  s_add_u32 s56, s56, 0xa00000
  v_mov_b32 v64, s40
  v_mov_b32 v65, s41
  v_mov_b32 v66, s42
  v_mov_b32 v67, s43
  s_mov_b64 exec, 0xff
  buffer_store_dwordx4 v[64:67], v6, s[28:31], s56 offen sc1
  s_mov_b64 exec, -1
  s_waitcnt vmcnt(5)
  s_barrier
  s_add_u32 m0, s36, 0x20000
  s_nop 0
  buffer_load_dwordx4 v20, s[48:51], s33 offen offset:0  lds
  buffer_load_dwordx4 v21, s[48:51], s33 offen offset:1024  lds
  s_add_u32 s33, s33, s34
  s_add_u32 s32, s32, 128
  s_and_b32 s32, s32, 0x3ff
  s_cselect_b32 s33, s33, 0
  v_mov_b32 v32, -1
  v_mov_b32 v33, -1
  v_mov_b32 v34, -1
  v_mov_b32 v35, -1
  s_lshl_b32 s56, s2, 14
  s_add_u32 s56, s56, s35
  s_add_u32 s56, s56, 0x600000
  buffer_store_dwordx4 v[32:35], v6, s[28:31], s56 offen offset:0 sc1
  buffer_store_dwordx4 v[32:35], v6, s[28:31], s56 offen offset:1024 sc1
  buffer_store_dwordx4 v[32:35], v6, s[28:31], s56 offen offset:2048 sc1
  buffer_store_dwordx4 v[32:35], v6, s[28:31], s56 offen offset:3072 sc1
  s_waitcnt vmcnt(9)
  s_barrier
  s_add_u32 m0, s36, 0x22000
  s_nop 0
  buffer_load_dwordx4 v20, s[48:51], s33 offen offset:0  lds
  buffer_load_dwordx4 v21, s[48:51], s33 offen offset:1024  lds
  s_add_u32 s33, s33, s34
  s_add_u32 s32, s32, 128
  s_and_b32 s32, s32, 0x3ff
  s_cselect_b32 s33, s33, 0
  s_waitcnt lgkmcnt(0)
  s_cmp_eq_u32 s4, 32
  s_cbranch_scc1 Linit1x
  s_cmp_lg_u32 s54, 4
  s_cbranch_scc1 Linit1x
  s_mov_b64 exec, 1
  s_mov_b32 s42, 0
  s_branch Lpoll2l
Lpoll2:
  s_sleep 16
Lpoll2l:
  global_load_dword v40, v8, s[62:63] sc1
  s_waitcnt vmcnt(0)
Lpoll2c:
  v_cmp_gt_u32 vcc, 32, v40
  s_add_u32 s42, s42, 1
  s_cmp_ge_u32 s42, 65536
  s_cbranch_scc1 Lpoll2x
  s_and_b64 exec, exec, vcc
  s_cbranch_scc1 Lpoll2
Lpoll2x:
  s_mov_b64 exec, -1
Linit1x:
  s_waitcnt vmcnt(9)
  s_barrier
  s_cmp_lg_u32 s54, 4
  s_cbranch_scc1 Lpub3
  v_mov_b32 v1, 1
  s_lshl_b32 s56, s2, 7
  s_add_u32 s56, s56, 0xa40000
  s_mov_b64 exec, 1
  buffer_store_dword v1, v6, s[28:31], s56 offen sc1
  s_mov_b64 exec, -1
Lpub3:
  s_add_u32 m0, s36, 0x24000
  s_nop 0
  buffer_load_dwordx4 v20, s[48:51], s33 offen offset:0  lds
  buffer_load_dwordx4 v21, s[48:51], s33 offen offset:1024  lds
  s_add_u32 s33, s33, s34
  s_add_u32 s32, s32, 128
  s_and_b32 s32, s32, 0x3ff
  s_cselect_b32 s33, s33, 0
  s_cmp_eq_u32 s54, 4
  s_cbranch_scc1 Lw4
  s_waitcnt vmcnt(8)
Lw4:
  s_waitcnt vmcnt(9)
  s_barrier
  s_add_u32 m0, s36, 0x26000
  s_nop 0
  buffer_load_dwordx4 v20, s[48:51], s33 offen offset:0  lds
  buffer_load_dwordx4 v21, s[48:51], s33 offen offset:1024  lds
  s_bfe_u32 s56, s2, 0x40003
  s_lshl_b32 s56, s56, 2
  s_add_u32 s56, s56, s16
  s_lshl_b32 s56, s56, 13
  v_lshlrev_b32 v1, 7, v0
  buffer_load_dword v41, v1, s[96:99], s56 offen
  s_cmp_eq_u32 s54, 4
  s_cbranch_scc1 Lw5
  s_waitcnt vmcnt(5)
Lw5:
  s_waitcnt vmcnt(6)
  s_barrier
  s_waitcnt vmcnt(3)
  s_barrier
  s_and_b32 s16, s2, 7
  s_lshl_b32 s17, s16, 2
  s_bfe_u32 s18, s2, 0x20003
  s_or_b32 s17, s17, s18
  s_lshr_b32 s19, s2, 5
  s_lshl_b32 s32, s17, 16
  s_lshl_b32 s33, s19, 1
  s_and_b32 s34, s54, 3
  s_add_u32 s35, s33, s34
  s_sub_u32 s36, s35, 2
  s_cselect_b32 s35, s35, s36
  s_lshr_b32 s36, s34, 1
  s_add_u32 s36, s36, s33
  s_lshr_b32 s37, s16, 2
  s_lshl_b32 s37, s37, 1
  s_and_b32 s38, s16, 3
  s_lshl_b32 s38, s38, 6
  s_lshr_b32 s39, s36, 3
  s_and_b32 s46, s36, 7
  s_lshl_b32 s46, s46, 3
  s_or_b32 s46, s46, s39
  s_or_b32 s46, s46, s37
  s_or_b32 s46, s46, s38
  s_add_u32 s37, s37, 4
  s_lshr_b32 s39, s35, 3
  s_and_b32 s47, s35, 7
  s_lshl_b32 s47, s47, 3
  s_or_b32 s47, s47, s39
  s_or_b32 s47, s47, s37
  s_or_b32 s47, s47, s38
  s_lshl_b32 s46, s46, 7
  s_lshl_b32 s47, s47, 7
  v_mov_b32 v2, s46
  v_writelane_b32 v2, s47, 1
  s_lshl_b32 s35, s35, 12
  s_add_u32 s35, s35, s32
  s_add_u32 s35, s35, 0x200000
  s_lshl_b32 s36, s19, 13
  s_add_u32 s36, s36, s32
  s_lshl_b32 s37, s34, 11
  s_add_u32 s36, s36, s37
  s_mov_b32 s47, 0xa40000
  s_mov_b64 exec, 3
  buffer_load_dword v4, v2, s[28:31], s47 offen sc1
  s_mov_b64 exec, -1
  s_waitcnt vmcnt(2)
  s_barrier
  s_branch P2_kq
P1_LA:
  s_waitcnt vmcnt(12)
  s_barrier
  s_add_u32 m0, s35, 0x0
  s_nop 0
  buffer_load_dwordx4 v16, s[24:27], s32 offen offset:0 lds
  buffer_load_dwordx4 v17, s[24:27], s32 offen offset:1024 lds
  buffer_load_dwordx4 v18, s[24:27], s32 offen offset:2048 lds
  buffer_load_dwordx4 v19, s[24:27], s32 offen offset:3072 lds
  s_add_u32 m0, s36, 0x20000
  s_nop 0
  buffer_load_dwordx4 v20, s[48:51], s33 offen offset:0  lds
  buffer_load_dwordx4 v21, s[48:51], s33 offen offset:1024  lds
  s_add_u32 s33, s33, s34
  s_add_u32 s32, s32, 128
  s_and_b32 s32, s32, 0x3ff
  s_cselect_b32 s33, s33, 0
  s_waitcnt vmcnt(12)
  s_barrier
  s_add_u32 m0, s35, 0x4000
  s_nop 0
  buffer_load_dwordx4 v16, s[24:27], s32 offen offset:0 lds
  buffer_load_dwordx4 v17, s[24:27], s32 offen offset:1024 lds
  buffer_load_dwordx4 v18, s[24:27], s32 offen offset:2048 lds
  buffer_load_dwordx4 v19, s[24:27], s32 offen offset:3072 lds
  s_add_u32 m0, s36, 0x22000
  s_nop 0
  buffer_load_dwordx4 v20, s[48:51], s33 offen offset:0  lds
  buffer_load_dwordx4 v21, s[48:51], s33 offen offset:1024  lds
  s_add_u32 s33, s33, s34
  s_add_u32 s32, s32, 128
  s_and_b32 s32, s32, 0x3ff
  s_cselect_b32 s33, s33, 0
  s_waitcnt vmcnt(12)
  s_barrier
  s_add_u32 m0, s35, 0x8000
  s_nop 0
  buffer_load_dwordx4 v16, s[24:27], s32 offen offset:0 lds
  buffer_load_dwordx4 v17, s[24:27], s32 offen offset:1024 lds
  buffer_load_dwordx4 v18, s[24:27], s32 offen offset:2048 lds
  buffer_load_dwordx4 v19, s[24:27], s32 offen offset:3072 lds
  s_add_u32 m0, s36, 0x24000
  s_nop 0
  buffer_load_dwordx4 v20, s[48:51], s33 offen offset:0  lds
  buffer_load_dwordx4 v21, s[48:51], s33 offen offset:1024  lds
  s_add_u32 s33, s33, s34
  s_add_u32 s32, s32, 128
  s_and_b32 s32, s32, 0x3ff
  s_cselect_b32 s33, s33, 0
  s_waitcnt vmcnt(12)
  s_barrier
  s_add_u32 m0, s35, 0xc000
  s_nop 0
  buffer_load_dwordx4 v16, s[24:27], s32 offen offset:0 lds
  buffer_load_dwordx4 v17, s[24:27], s32 offen offset:1024 lds
  buffer_load_dwordx4 v18, s[24:27], s32 offen offset:2048 lds
  buffer_load_dwordx4 v19, s[24:27], s32 offen offset:3072 lds
  s_add_u32 m0, s36, 0x26000
  s_nop 0
  buffer_load_dwordx4 v20, s[48:51], s33 offen offset:0  lds
  buffer_load_dwordx4 v21, s[48:51], s33 offen offset:1024  lds
  s_add_u32 s33, s33, s34
  s_add_u32 s32, s32, 128
  s_and_b32 s32, s32, 0x3ff
  s_cselect_b32 s33, s33, 0
  s_load_dword s4, s[62:63], 0
  s_waitcnt vmcnt(12)
  s_barrier
  s_add_u32 m0, s35, 0x10000
  s_nop 0
  buffer_load_dwordx4 v16, s[24:27], s32 offen offset:0 lds
  buffer_load_dwordx4 v17, s[24:27], s32 offen offset:1024 lds
  buffer_load_dwordx4 v18, s[24:27], s32 offen offset:2048 lds
  buffer_load_dwordx4 v19, s[24:27], s32 offen offset:3072 lds
  s_add_u32 m0, s36, 0x20000
  s_nop 0
  buffer_load_dwordx4 v20, s[48:51], s33 offen offset:0  lds
  buffer_load_dwordx4 v21, s[48:51], s33 offen offset:1024  lds
  s_add_u32 s33, s33, s34
  s_add_u32 s32, s32, 128
  s_and_b32 s32, s32, 0x3ff
  s_cselect_b32 s33, s33, 0
  s_waitcnt vmcnt(12)
  s_barrier
  s_add_u32 m0, s35, 0x14000
  s_nop 0
  buffer_load_dwordx4 v16, s[24:27], s32 offen offset:0 lds
  buffer_load_dwordx4 v17, s[24:27], s32 offen offset:1024 lds
  buffer_load_dwordx4 v18, s[24:27], s32 offen offset:2048 lds
  buffer_load_dwordx4 v19, s[24:27], s32 offen offset:3072 lds
  s_add_u32 m0, s36, 0x22000
  s_nop 0
  buffer_load_dwordx4 v20, s[48:51], s33 offen offset:0  lds
  buffer_load_dwordx4 v21, s[48:51], s33 offen offset:1024  lds
  s_add_u32 s33, s33, s34
  s_add_u32 s32, s32, 128
  s_and_b32 s32, s32, 0x3ff
  s_cselect_b32 s33, s33, 0
  s_waitcnt lgkmcnt(0)
  s_cmp_eq_u32 s4, 32
  s_cbranch_scc1 Linit6x
  s_cmp_lg_u32 s54, 4
  s_cbranch_scc1 Linit6x
  s_mov_b64 exec, 1
  s_mov_b32 s42, 0
  s_branch Lpoll7l
Lpoll7:
  s_sleep 16
Lpoll7l:
  global_load_dword v40, v8, s[62:63] sc1
  s_waitcnt vmcnt(0)
Lpoll7c:
  v_cmp_gt_u32 vcc, 32, v40
  s_add_u32 s42, s42, 1
  s_cmp_ge_u32 s42, 65536
  s_cbranch_scc1 Lpoll7x
  s_and_b64 exec, exec, vcc
  s_cbranch_scc1 Lpoll7
Lpoll7x:
  s_mov_b64 exec, -1
Linit6x:
  s_waitcnt vmcnt(12)
  s_barrier
  s_cmp_lg_u32 s54, 4
  s_cbranch_scc1 Lpub8
  v_mov_b32 v1, 1
  s_lshl_b32 s56, s2, 7
  s_add_u32 s56, s56, 0xa40000
  s_mov_b64 exec, 1
  buffer_store_dword v1, v6, s[28:31], s56 offen sc1
  s_mov_b64 exec, -1
Lpub8:
  s_add_u32 m0, s35, 0x18000
  s_nop 0
  buffer_load_dwordx4 v16, s[24:27], s32 offen offset:0 lds
  buffer_load_dwordx4 v17, s[24:27], s32 offen offset:1024 lds
  buffer_load_dwordx4 v18, s[24:27], s32 offen offset:2048 lds
  buffer_load_dwordx4 v19, s[24:27], s32 offen offset:3072 lds
  s_add_u32 m0, s36, 0x24000
  s_nop 0
  buffer_load_dwordx4 v20, s[48:51], s33 offen offset:0  lds
  buffer_load_dwordx4 v21, s[48:51], s33 offen offset:1024  lds
  s_add_u32 s33, s33, s34
  s_add_u32 s32, s32, 128
  s_and_b32 s32, s32, 0x3ff
  s_cselect_b32 s33, s33, 0
  s_cmp_eq_u32 s54, 4
  s_cbranch_scc1 Lw9
  s_waitcnt vmcnt(12)
Lw9:
  s_waitcnt vmcnt(13)
  s_barrier
  s_add_u32 m0, s35, 0x1c000
  s_nop 0
  buffer_load_dwordx4 v16, s[24:27], s32 offen offset:0 lds
  buffer_load_dwordx4 v17, s[24:27], s32 offen offset:1024 lds
  buffer_load_dwordx4 v18, s[24:27], s32 offen offset:2048 lds
  buffer_load_dwordx4 v19, s[24:27], s32 offen offset:3072 lds
  s_add_u32 m0, s36, 0x26000
  s_nop 0
  buffer_load_dwordx4 v20, s[48:51], s33 offen offset:0  lds
  buffer_load_dwordx4 v21, s[48:51], s33 offen offset:1024  lds
  s_cmp_eq_u32 s54, 4
  s_cbranch_scc1 Lw10
  s_waitcnt vmcnt(12)
Lw10:
  s_waitcnt vmcnt(13)
  s_barrier
  s_waitcnt vmcnt(6)
  s_barrier
  s_and_b32 s16, s2, 7
  s_lshl_b32 s17, s16, 2
  s_bfe_u32 s18, s2, 0x20003
  s_or_b32 s17, s17, s18
  s_lshr_b32 s19, s2, 5
  s_lshl_b32 s32, s17, 16
  s_lshl_b32 s33, s19, 1
  s_and_b32 s34, s54, 3
  s_add_u32 s35, s33, s34
  s_sub_u32 s36, s35, 2
  s_cselect_b32 s35, s35, s36
  s_lshr_b32 s36, s34, 1
  s_add_u32 s36, s36, s33
  s_lshr_b32 s37, s16, 2
  s_lshl_b32 s37, s37, 1
  s_and_b32 s38, s16, 3
  s_lshl_b32 s38, s38, 6
  s_lshr_b32 s39, s36, 3
  s_and_b32 s46, s36, 7
  s_lshl_b32 s46, s46, 3
  s_or_b32 s46, s46, s39
  s_or_b32 s46, s46, s37
  s_or_b32 s46, s46, s38
  s_add_u32 s37, s37, 4
  s_lshr_b32 s39, s35, 3
  s_and_b32 s47, s35, 7
  s_lshl_b32 s47, s47, 3
  s_or_b32 s47, s47, s39
  s_or_b32 s47, s47, s37
  s_or_b32 s47, s47, s38
  s_lshl_b32 s46, s46, 7
  s_lshl_b32 s47, s47, 7
  v_mov_b32 v2, s46
  v_writelane_b32 v2, s47, 1
  s_lshl_b32 s35, s35, 12
  s_add_u32 s35, s35, s32
  s_add_u32 s35, s35, 0x200000
  s_lshl_b32 s36, s19, 13
  s_add_u32 s36, s36, s32
  s_lshl_b32 s37, s34, 11
  s_add_u32 s36, s36, s37
  s_mov_b32 s47, 0xa40000
  s_mov_b64 exec, 3
  buffer_load_dword v4, v2, s[28:31], s47 offen sc1
  s_mov_b64 exec, -1
  s_waitcnt vmcnt(1)
  s_barrier
  s_branch P2_kq
P1_compute:
  s_and_b32 s45, s16, 1
  s_lshr_b32 s46, s16, 1
  v_and_b32 v7, 31, v0
  v_lshrrev_b32 v8, 5, v0
  v_and_b32 v4, 0x13, v7
  v_and_b32 v5, 4, v7
  v_lshl_or_b32 v4, v5, 1, v4
  v_and_b32 v5, 8, v7
  v_lshrrev_b32 v5, 1, v5
  v_or_b32 v9, v4, v5
  s_lshl_b32 s47, s46, 13
  v_lshl_add_u32 v4, v9, 7, s47
  v_lshrrev_b32 v5, 1, v9
  v_and_b32 v5, 7, v5
  v_xor_b32 v5, v5, v8
  v_xor_b32 v6, 0, v5
  v_lshl_add_u32 v10, v6, 4, v4
  v_xor_b32 v6, 2, v5
  v_lshl_add_u32 v11, v6, 4, v4
  v_xor_b32 v6, 4, v5
  v_lshl_add_u32 v12, v6, 4, v4
  v_xor_b32 v6, 6, v5
  v_lshl_add_u32 v13, v6, 4, v4
  v_lshrrev_b32 v4, 2, v0
  v_and_b32 v4, 3, v4
  v_lshl_add_u32 v5, v8, 3, v4
  v_lshlrev_b32 v5, 7, v5
  v_lshrrev_b32 v4, 1, v4
  v_xor_b32 v4, s45, v4
  v_lshl_add_u32 v5, v4, 6, v5
  v_and_b32 v4, 16, v0
  v_lshl_add_u32 v5, v4, 1, v5
  v_and_b32 v4, 1, v0
  v_lshl_add_u32 v5, v4, 4, v5
  v_and_b32 v4, 2, v0
  v_lshl_add_u32 v5, v4, 2, v5
  v_add_u32 v14, 0x20000, v5
  v_mov_b32 v148, 0
  v_mov_b32 v149, 0
  v_mov_b32 v150, 0
  v_mov_b32 v151, 0
  v_mov_b32 v152, 0
  v_mov_b32 v153, 0
  v_mov_b32 v154, 0
  v_mov_b32 v155, 0
  v_mov_b32 v156, 0
  v_mov_b32 v157, 0
  v_mov_b32 v158, 0
  v_mov_b32 v159, 0
  v_mov_b32 v160, 0
  v_mov_b32 v161, 0
  v_mov_b32 v162, 0
  v_mov_b32 v163, 0
  v_mov_b32 v164, 0
  v_mov_b32 v165, 0
  v_mov_b32 v166, 0
  v_mov_b32 v167, 0
  v_mov_b32 v168, 0
  v_mov_b32 v169, 0
  v_mov_b32 v170, 0
  v_mov_b32 v171, 0
  v_mov_b32 v172, 0
  v_mov_b32 v173, 0
  v_mov_b32 v174, 0
  v_mov_b32 v175, 0
  v_mov_b32 v176, 0
  v_mov_b32 v177, 0
  v_mov_b32 v178, 0
  v_mov_b32 v179, 0
  v_mov_b32 v116, 0
  v_mov_b32 v117, 0
  v_mov_b32 v118, 0
  v_mov_b32 v119, 0
  v_mov_b32 v120, 0
  v_mov_b32 v121, 0
  v_mov_b32 v122, 0
  v_mov_b32 v123, 0
  v_mov_b32 v124, 0
  v_mov_b32 v125, 0
  v_mov_b32 v126, 0
  v_mov_b32 v127, 0
  v_mov_b32 v128, 0
  v_mov_b32 v129, 0
  v_mov_b32 v130, 0
  v_mov_b32 v131, 0
  v_mov_b32 v132, 0
  v_mov_b32 v133, 0
  v_mov_b32 v134, 0
  v_mov_b32 v135, 0
  v_mov_b32 v136, 0
  v_mov_b32 v137, 0
  v_mov_b32 v138, 0
  v_mov_b32 v139, 0
  v_mov_b32 v140, 0
  v_mov_b32 v141, 0
  v_mov_b32 v142, 0
  v_mov_b32 v143, 0
  v_mov_b32 v144, 0
  v_mov_b32 v145, 0
  v_mov_b32 v146, 0
  v_mov_b32 v147, 0
  v_lshlrev_b32 v4, 4, v0
  s_waitcnt lgkmcnt(0)
  s_mov_b32 s28, s14
  s_mov_b32 s29, s15
  s_mov_b32 s30, 0xb00000
  s_mov_b32 s31, 0x20000
  s_xor_b32 s49, s54, 1
  s_lshl_b32 s49, s49, 8
  s_add_u32 s49, s49, s2
  s_sub_u32 s49, s49, 0
  s_cmp_ge_u32 s49, 32
  s_cbranch_scc1 P1_init2
  s_mul_i32 s48, s49, 2048
  s_cmp_lg_u32 s48, 0
  s_cbranch_scc1 P1_init1
  s_mov_b32 s47, 0xa50000
  buffer_store_dwordx4 v[148:151], v4, s[28:31], s47 offen sc1
P1_init1:
  s_add_u32 s48, s48, 0xa40000
  buffer_store_dwordx4 v[148:151], v4, s[28:31], s48 offen offset:0 sc1
  buffer_store_dwordx4 v[148:151], v4, s[28:31], s48 offen offset:1024 sc1
P1_init2:
  v_lshlrev_b32 v251, 4, v0
  v_and_b32 v36, 31, v0
  v_lshrrev_b32 v37, 5, v0
  v_and_b32 v38, 0x13, v36
  v_and_b32 v39, 4, v36
  v_lshl_or_b32 v38, v39, 1, v38
  v_and_b32 v39, 8, v36
  v_lshrrev_b32 v39, 1, v39
  v_or_b32 v248, v38, v39
  v_lshlrev_b32 v38, 3, v37
  v_sub_u32 v38, v248, v38
  v_cmp_le_i32 s[64:65], 0, v38
  v_cmp_le_i32 s[66:67], 1, v38
  v_cmp_le_i32 s[68:69], 2, v38
  v_cmp_le_i32 s[70:71], 3, v38
  v_cmp_le_i32 s[72:73], 4, v38
  v_cmp_le_i32 s[74:75], 5, v38
  v_cmp_le_i32 s[76:77], 6, v38
  v_cmp_le_i32 s[78:79], 7, v38
  v_cmp_le_i32 s[80:81], 16, v38
  v_cmp_le_i32 s[82:83], 17, v38
  v_cmp_le_i32 s[84:85], 18, v38
  v_cmp_le_i32 s[86:87], 19, v38
  v_cmp_le_i32 s[88:89], 20, v38
  v_cmp_le_i32 s[90:91], 21, v38
  v_cmp_le_i32 s[92:93], 22, v38
  v_cmp_le_i32 s[94:95], 23, v38
  v_mov_b32 v39, 0xffff
  v_mov_b32 v248, 0xffff0000
  v_cndmask_b32 v232, 0, v39, s[64:65]
  v_cndmask_b32 v38, 0, v248, s[66:67]
  v_or_b32 v232, v232, v38
  v_cndmask_b32 v233, 0, v39, s[68:69]
  v_cndmask_b32 v38, 0, v248, s[70:71]
  v_or_b32 v233, v233, v38
  v_cndmask_b32 v234, 0, v39, s[72:73]
  v_cndmask_b32 v38, 0, v248, s[74:75]
  v_or_b32 v234, v234, v38
  v_cndmask_b32 v235, 0, v39, s[76:77]
  v_cndmask_b32 v38, 0, v248, s[78:79]
  v_or_b32 v235, v235, v38
  v_cndmask_b32 v236, 0, v39, s[80:81]
  v_cndmask_b32 v38, 0, v248, s[82:83]
  v_or_b32 v236, v236, v38
  v_cndmask_b32 v237, 0, v39, s[84:85]
  v_cndmask_b32 v38, 0, v248, s[86:87]
  v_or_b32 v237, v237, v38
  v_cndmask_b32 v238, 0, v39, s[88:89]
  v_cndmask_b32 v38, 0, v248, s[90:91]
  v_or_b32 v238, v238, v38
  v_cndmask_b32 v239, 0, v39, s[92:93]
  v_cndmask_b32 v38, 0, v248, s[94:95]
  v_or_b32 v239, v239, v38
  s_cmp_lt_u32 s2, 32
  s_cselect_b32 s96, 0xff800000, 0
  v_mov_b32 v216, s96
  v_mov_b32 v217, s96
  v_mov_b32 v218, s96
  v_mov_b32 v219, s96
  v_mov_b32 v220, s96
  v_mov_b32 v221, s96
  v_mov_b32 v222, s96
  v_mov_b32 v223, s96
  v_mov_b32 v224, s96
  v_mov_b32 v225, s96
  v_mov_b32 v226, s96
  v_mov_b32 v227, s96
  v_mov_b32 v228, s96
  v_mov_b32 v229, s96
  v_mov_b32 v230, s96
  v_mov_b32 v231, s96
  v_mov_b32 v249, 0xff800000
  s_lshl_b32 s96, s54, 10
  v_add_u32 v253, s96, v251
  v_and_b32 v38, 15, v0
  v_lshl_add_u32 v38, v37, 4, v38
  v_lshl_add_u32 v38, v38, 4, s96
  v_and_b32 v39, 16, v0
  v_lshl_add_u32 v254, v39, 10, v38
  s_and_b32 s98, s2, 7
  s_lshl_b32 s98, s98, 1
  s_bfe_u32 s99, s2, 0x10003
  s_or_b32 s98, s98, s99
  s_sub_u32 s99, 32, s98
  s_cmp_eq_u32 s98, 0
  s_cselect_b32 s99, 16, s99
  s_bitcmp1_b32 s2, 4
  s_cselect_b32 s96, s99, s98
  s_lshr_b32 s97, s2, 5
  s_lshr_b32 s99, s96, 2
  s_lshl_b32 s99, s99, 7
  v_lshl_add_u32 v245, v36, 10, s99
  s_and_b32 s96, s96, 3
  s_lshl_b32 s96, s96, 2
  s_and_b32 s99, s54, 1
  s_lshl_b32 s99, s99, 15
  s_add_u32 s96, s96, s99
  s_add_u32 s96, s96, 0xa00000
  v_add_u32 v245, s96, v245
  v_and_b32 v38, 4, v0
  v_lshlrev_b32 v38, 2, v38
  v_bfe_u32 v39, v0, 3, 2
  v_lshl_add_u32 v38, v39, 2, v38
  v_and_b32 v39, 3, v0
  v_add_u32 v38, v38, v39
  s_lshl_b32 s98, s98, 17
  s_add_u32 s98, s98, s99
  s_lshl_b32 s96, s97, 6
  s_bfe_u32 s99, s54, 0x10001
  s_lshl_b32 s99, s99, 5
  s_add_u32 s96, s96, s99
  v_add_u32 v38, s96, v38
  v_sub_u32 v39, 0x200, v38
  v_min_u32 v39, v38, v39
  v_and_b32 v38, 0xff, v38
  s_lshr_b32 s99, s54, 2
  s_sub_u32 s96, s99, 1
  v_cmp_eq_u32 vcc, s96, v38
  s_lshl_b32 s99, s99, 12
  s_add_u32 s98, s98, s99
  s_add_u32 s98, s98, 0x600000
  v_lshl_add_u32 v38, v37, 16, s98
  v_lshl_add_u32 v250, v39, 4, v38
  v_mov_b32 v38, 0x7f000000
  v_cndmask_b32 v250, v250, v38, vcc
  s_sub_u32 s96, 7, s97
  s_min_u32 s96, s96, s97
  s_and_b32 s98, s54, 4
  s_add_u32 s96, s96, s98
  s_lshr_b32 s98, s97, 2
  s_add_u32 s98, s98, s96
  s_min_u32 s98, s98, 7
  v_mov_b32 v38, s96
  v_mov_b32 v39, s98
  v_and_b32 v36, 8, v0
  v_cmp_eq_u32 vcc, 0, v36
  v_and_b32 v36, 3, v0
  v_lshlrev_b32 v36, 3, v36
  v_cndmask_b32 v38, v39, v38, vcc
  v_and_b32 v39, 4, v0
  v_add_u32 v36, v36, v39
  v_lshrrev_b32 v39, 2, v38
  v_add_u32 v36, v36, v39
  v_and_b32 v38, 3, v38
  v_lshl_add_u32 v36, v38, 5, v36
  s_and_b32 s96, s54, 1
  s_lshl_b32 s96, s96, 8
  s_and_b32 s98, s2, 4
  s_lshl_b32 s98, s98, 1
  s_add_u32 s96, s96, s98
  s_add_u32 s96, s96, 0xa48000
  v_lshl_add_u32 v252, v36, 7, s96
  v_lshrrev_b32 v38, 3, v0
  v_bfe_u32 v39, v0, 4, 1
  v_lshlrev_b32 v39, 2, v39
  v_and_b32 v36, 7, v0
  v_and_b32 v255, 3, v0
  v_lshlrev_b32 v255, 7, v255
  v_add_u32 v255, 0xa50200, v255
  v_xor_b32 v36, v36, v39
  v_lshlrev_b32 v36, 4, v36
  v_lshl_add_u32 v36, v38, 10, v36
  s_bfe_u32 s99, s2, 0x20003
  s_mul_i32 s99, s99, 2
  s_add_u32 s99, s99, s54
  s_and_b32 s99, s99, 7
  s_lshl_b32 s1, s99, 13
  s_add_u32 s1, s1, 0x18000
  s_lshl_b32 s99, s99, 16
  s_lshl_b32 s97, s97, 7
  s_add_u32 s99, s99, s97
  v_add_u32 v244, s99, v36
  s_mov_b32 s0, 0
  s_mov_b32 s96, s58
  s_mov_b32 s97, s59
  s_mov_b32 s98, 0x80000
  s_mov_b32 s99, 0x20000
  v_lshrrev_b32 v37, 5, v0
  s_and_b32 s6, s2, 7
  s_lshl_b32 s6, s6, 1
  s_bfe_u32 s7, s2, 0x10003
  s_or_b32 s6, s6, s7
  s_sub_u32 s7, 32, s6
  s_cmp_eq_u32 s6, 0
  s_cselect_b32 s7, 16, s7
  s_bitcmp1_b32 s2, 4
  s_cselect_b32 s4, s7, s6
  s_lshr_b32 s5, s2, 5
  v_and_b32 v36, 31, v0
  s_and_b32 s7, s54, 1
  s_lshl_b32 s7, s7, 10
  s_lshl_b32 s8, s4, 16
  s_add_u32 s8, s8, s7
  s_add_u32 s7, s7, s4
  v_lshl_add_u32 v36, v36, 5, s7
  s_and_b32 s7, s54, 6
  s_lshl_b32 s7, s7, 13
  s_add_u32 s8, s8, s7
  s_add_u32 s8, s8, 0x800000
  v_add_u32 v211, s8, v251
  v_lshlrev_b32 v38, 10, v36
  v_lshl_add_u32 v38, v37, 5, v38
  s_lshl_b32 s8, s5, 7
  s_and_b32 s7, s54, 4
  s_lshl_b32 s7, s7, 4
  s_add_u32 s8, s8, s7
  s_and_b32 s7, s54, 2
  s_lshl_b32 s7, s7, 3
  s_add_u32 s8, s8, s7
  v_add_u32 v206, s8, v38
  v_cvt_f32_u32 v36, v36
  s_cmp_gt_u32 s4, 16
  s_mov_b32 s8, 0x3a000000
  s_cselect_b32 s8, 0xba000000, s8
  s_cselect_b32 s4, 1, 0
  v_mul_f32 v36, s8, v36
  s_lshr_b32 s8, s5, 2
  s_xor_b32 s4, s4, s8
  s_cselect_b32 s4, 0x80008000, 0
  v_mov_b32 v214, s4
  v_xor_b32 v215, 0x80008000, v214
  s_and_b32 s8, s54, 6
  s_lshl_b32 s8, s8, 2
  s_cmp_ge_u32 s6, 8
  s_cselect_b32 s4, 2, 0
  s_cselect_b32 s6, 0xc0400000, 1.0
  s_cselect_b32 s7, 0x40a00000, 1.0
  s_add_u32 s8, s8, s4
  v_lshl_add_u32 v38, v37, 5, s8
  v_cvt_f32_u32 v38, v38
  v_mul_f32 v38, v38, v36
  v_fract_f32 v38, v38
  v_cos_f32 v188, v38
  v_sin_f32 v190, v38
  v_add_f32 v38, v38, v36
  v_cos_f32 v189, v38
  v_sin_f32 v191, v38
  v_fma_f32 v38, v36, s6, v38
  v_cos_f32 v192, v38
  v_sin_f32 v194, v38
  v_add_f32 v38, v38, v36
  v_cos_f32 v193, v38
  v_sin_f32 v195, v38
  v_fma_f32 v38, v36, s7, v38
  v_cos_f32 v196, v38
  v_sin_f32 v198, v38
  v_add_f32 v38, v38, v36
  v_cos_f32 v197, v38
  v_sin_f32 v199, v38
  v_fma_f32 v38, v36, s6, v38
  v_cos_f32 v200, v38
  v_sin_f32 v202, v38
  v_add_f32 v38, v38, v36
  v_cos_f32 v201, v38
  v_sin_f32 v203, v38
  v_fma_f32 v38, v36, s7, v38
  s_and_b32 s8, s54, 2
  s_lshl_b32 s8, s8, 7
  v_xor_b32 v38, s8, v251
  s_and_b32 s8, s54, 6
  s_lshl_b32 s8, s8, 10
  s_and_b32 s4, s54, 4
  s_lshl_b32 s4, s4, 11
  s_add_u32 s8, s8, s4
  s_add_u32 s8, s8, 0x10000
  v_add_u32 v204, s8, v38
  v_bfe_u32 v38, v0, 2, 2
  v_lshl_add_u32 v39, v37, 3, v38
  v_lshlrev_b32 v39, 7, v39
  v_lshrrev_b32 v38, 1, v38
  s_lshr_b32 s8, s54, 2
  v_xor_b32 v38, s8, v38
  v_lshl_add_u32 v39, v38, 6, v39
  v_and_b32 v38, 1, v0
  v_lshl_add_u32 v39, v38, 5, v39
  s_and_b32 s8, s54, 2
  s_lshl_b32 s8, s8, 3
  v_and_b32 v38, 16, v0
  v_xor_b32 v38, s8, v38
  v_add_u32 v39, v38, v39
  v_and_b32 v38, 2, v0
  v_lshl_add_u32 v39, v38, 2, v39
  s_and_b32 s8, s54, 6
  s_lshl_b32 s8, s8, 13
  s_mul_i32 s4, s5, 2048
  s_add_u32 s8, s8, s4
  s_add_u32 s8, s8, 0x18000
  v_add_u32 v205, s8, v39
  s_lshl_b32 s8, s54, 11
  v_add_u32 v207, s8, v251
  v_xor_b32 v208, 0x1000, v207
  v_xor_b32 v209, 0x2000, v207
  v_xor_b32 v210, 0x3000, v207
  v_and_b32 v36, 7, v0
  v_xor_b32 v38, s54, v36
  v_lshlrev_b32 v38, 4, v38
  v_lshl_add_u32 v212, v0, 7, v38
  v_lshrrev_b32 v38, 3, v0
  v_xor_b32 v36, v36, v38
  s_and_b32 s8, s54, 3
  s_lshl_b32 s8, s8, 3
  v_add_u32 v38, s8, v38
  v_and_b32 v39, 0x13, v38
  v_and_b32 v37, 4, v38
  v_lshl_or_b32 v39, v37, 1, v39
  v_and_b32 v37, 8, v38
  v_lshrrev_b32 v37, 1, v37
  v_or_b32 v38, v39, v37
  v_lshlrev_b32 v36, 4, v36
  v_lshl_add_u32 v36, v38, 16, v36
  s_and_b32 s8, s2, 7
  s_lshl_b32 s8, s8, 13
  s_bfe_u32 s4, s2, 0x20003
  s_lshl_b32 s4, s4, 11
  s_add_u32 s8, s8, s4
  s_lshr_b32 s4, s2, 7
  s_lshl_b32 s4, s4, 10
  s_add_u32 s8, s8, s4
  s_lshr_b32 s4, s54, 2
  s_lshl_b32 s4, s4, 9
  s_add_u32 s8, s8, s4
  s_bfe_u32 s4, s2, 0x20005
  s_lshl_b32 s4, s4, 7
  s_add_u32 s8, s8, s4
  s_add_u32 s8, s8, 0x800000
  v_add_u32 v213, s8, v36
  s_lshl_b32 s47, s21, 1
  s_or_b32 s47, s47, s45
  s_cmp_eq_u32 s47, 8
  s_cselect_b32 s56, s3, 0
  s_mov_b32 s57, s56
  v_mov_b32 v15, 0xbf803f80
  s_lshl_b32 s52, s2, 7
  s_add_u32 s52, s52, 0xa40000
  s_lshr_b32 s53, s2, 5
  s_lshl_b32 s53, s53, 7
  s_add_u32 s53, s53, 0xa50000
  v_mov_b32 v17, 1
  v_mov_b32 v18, 0
  s_lshl_b32 s43, s45, 3
  s_add_u32 s52, s52, s43
  s_lshl_b32 s43, s46, 2
  s_add_u32 s52, s52, s43
  s_cmp_lg_u32 s3, 0
  s_add_u32 s42, s54, s3
  s_lshl_b32 s42, s42, 4
  s_add_u32 s42, s42, 3
  s_cmp_lg_u32 s3, 0
  s_mov_b32 s38, 0x8000
  s_mov_b32 s39, 0xfffe8000
  s_mov_b32 s44, 0
  s_cbranch_scc0 P1_noT
  s_lshl_b32 s47, s46, 4
  v_xor_b32 v1, s47, v7
  v_lshrrev_b32 v4, 1, v1
  v_cmp_eq_u32 vcc, 1, v1
  v_and_b32 v5, 1, v1
  v_lshlrev_b32 v6, 3, v8
  v_cndmask_b32 v4, v4, 16, vcc
  v_cndmask_b32 v5, v5, 0, vcc
  v_cvt_f32_u32 v4, v4
  v_mul_f32 v4, 0x3d000000, v4
  v_cvt_f32_u32 v5, v5
  v_mul_f32 v5, 0x3e800000, v5
  v_cvt_f32_u32 v6, v6
  v_fma_f32 v5, v6, v4, v5
  v_mul_f32 v6, 0x41100000, v4
  v_cos_f32 v1, v5
  v_add_f32 v5, v5, v4
  v_cos_f32 v2, v5
  v_add_f32 v5, v5, v4
  v_cvt_pk_bf16_f32 v180, v1, v2
  v_cos_f32 v1, v5
  v_add_f32 v5, v5, v4
  v_cos_f32 v2, v5
  v_add_f32 v5, v5, v4
  v_cvt_pk_bf16_f32 v181, v1, v2
  v_cos_f32 v1, v5
  v_add_f32 v5, v5, v4
  v_cos_f32 v2, v5
  v_add_f32 v5, v5, v4
  v_cvt_pk_bf16_f32 v182, v1, v2
  v_cos_f32 v1, v5
  v_add_f32 v5, v5, v4
  v_cos_f32 v2, v5
  v_add_f32 v5, v5, v6
  v_cvt_pk_bf16_f32 v183, v1, v2
  v_cos_f32 v1, v5
  v_add_f32 v5, v5, v4
  v_cos_f32 v2, v5
  v_add_f32 v5, v5, v4
  v_cvt_pk_bf16_f32 v184, v1, v2
  v_cos_f32 v1, v5
  v_add_f32 v5, v5, v4
  v_cos_f32 v2, v5
  v_add_f32 v5, v5, v4
  v_cvt_pk_bf16_f32 v185, v1, v2
  v_cos_f32 v1, v5
  v_add_f32 v5, v5, v4
  v_cos_f32 v2, v5
  v_add_f32 v5, v5, v4
  v_cvt_pk_bf16_f32 v186, v1, v2
  v_cos_f32 v1, v5
  v_add_f32 v5, v5, v4
  v_cos_f32 v2, v5
  v_add_f32 v5, v5, v6
  v_cvt_pk_bf16_f32 v187, v1, v2
P1_noT:
  s_cmp_lt_u32 s19, 8
  s_cselect_b32 s40, 0x3eb8aa3b, 1.0
  s_mov_b32 s41, s40
  s_lshl_b32 s47, s46, 11
  s_lshl_b32 s48, s45, 17
  s_add_u32 s47, s47, s48
  v_lshl_add_u32 v16, v0, 4, s47
  s_lshl_b32 s50, s19, 18
  s_lshl_b32 s48, s18, 12
  s_add_u32 s50, s50, s48
  s_add_u32 s51, s50, 0x10000
  s_waitcnt vmcnt(0)
  s_cmp_ge_u32 s49, 32
  s_cbranch_scc1 P1_noinit
  s_mov_b64 exec, 1
  global_atomic_add v18, v17, s[62:63] sc1
  s_mov_b64 exec, -1
P1_noinit:
  s_barrier
  ds_read_b64_tr_b16 v[28:29], v14 offset:0
  ds_read_b64_tr_b16 v[30:31], v14 offset:512
  ds_read_b128 v[20:23], v10 offset:0
  ds_read_b128 v[24:27], v10 offset:4096
  ds_read_b64_tr_b16 v[40:41], v14 offset:2048
  ds_read_b64_tr_b16 v[42:43], v14 offset:2560
  ds_read_b128 v[32:35], v11 offset:0
  ds_read_b128 v[36:39], v11 offset:4096
  ds_read_b64_tr_b16 v[52:53], v14 offset:4096
  ds_read_b64_tr_b16 v[54:55], v14 offset:4608
  ds_read_b128 v[44:47], v12 offset:0
  ds_read_b128 v[48:51], v12 offset:4096
  ds_read_b64_tr_b16 v[64:65], v14 offset:6144
  ds_read_b64_tr_b16 v[66:67], v14 offset:6656
  s_waitcnt lgkmcnt(12)
  ds_read_b128 v[56:59], v13 offset:0
  ds_read_b128 v[60:63], v13 offset:4096
  s_mov_b32 s36, 0
P1_loop0:
  s_add_u32 s36, s36, 1
  s_cmp_lg_u32 s36, 4
  s_cselect_b32 s37, s38, s39
  s_waitcnt lgkmcnt(0)
  s_barrier
  ds_read_b64_tr_b16 v[76:77], v14 offset:8192
  ds_read_b64_tr_b16 v[78:79], v14 offset:8704
  v_mfma_f32_32x32x16_bf16 v[148:163], v[28:31], v[20:23], v[148:163]
  ds_read_b128 v[68:71], v10 offset:16384
  ds_read_b128 v[72:75], v10 offset:20480
  v_mfma_f32_32x32x16_bf16 v[164:179], v[28:31], v[24:27], v[164:179]
  ds_read_b64_tr_b16 v[88:89], v14 offset:10240
  ds_read_b64_tr_b16 v[90:91], v14 offset:10752
  v_mfma_f32_32x32x16_bf16 v[148:163], v[40:43], v[32:35], v[148:163]
  ds_read_b128 v[80:83], v11 offset:16384
  ds_read_b128 v[84:87], v11 offset:20480
  v_mfma_f32_32x32x16_bf16 v[164:179], v[40:43], v[36:39], v[164:179]
  ds_read_b64_tr_b16 v[100:101], v14 offset:12288
  ds_read_b64_tr_b16 v[102:103], v14 offset:12800
  v_mfma_f32_32x32x16_bf16 v[148:163], v[52:55], v[44:47], v[148:163]
  ds_read_b128 v[92:95], v12 offset:16384
  ds_read_b128 v[96:99], v12 offset:20480
  v_mfma_f32_32x32x16_bf16 v[164:179], v[52:55], v[48:51], v[164:179]
  ds_read_b64_tr_b16 v[112:113], v14 offset:14336
  ds_read_b64_tr_b16 v[114:115], v14 offset:14848
  v_mfma_f32_32x32x16_bf16 v[148:163], v[64:67], v[56:59], v[148:163]
  ds_read_b128 v[104:107], v13 offset:16384
  s_waitcnt lgkmcnt(12)
  ds_read_b128 v[108:111], v13 offset:20480
  v_mfma_f32_32x32x16_bf16 v[164:179], v[64:67], v[60:63], v[164:179]
  v_add_u32 v10, s37, v10
  v_add_u32 v11, s37, v11
  v_add_u32 v12, s37, v12
  v_add_u32 v13, s37, v13
  v_xor_b32 v14, 0x4000, v14
  s_waitcnt lgkmcnt(0)
  s_barrier
  ds_read_b64_tr_b16 v[28:29], v14 offset:0
  ds_read_b64_tr_b16 v[30:31], v14 offset:512
  v_mfma_f32_32x32x16_bf16 v[148:163], v[76:79], v[68:71], v[148:163]
  ds_read_b128 v[20:23], v10 offset:0
  ds_read_b128 v[24:27], v10 offset:4096
  v_mfma_f32_32x32x16_bf16 v[164:179], v[76:79], v[72:75], v[164:179]
  ds_read_b64_tr_b16 v[40:41], v14 offset:2048
  ds_read_b64_tr_b16 v[42:43], v14 offset:2560
  v_mfma_f32_32x32x16_bf16 v[148:163], v[88:91], v[80:83], v[148:163]
  ds_read_b128 v[32:35], v11 offset:0
  ds_read_b128 v[36:39], v11 offset:4096
  v_mfma_f32_32x32x16_bf16 v[164:179], v[88:91], v[84:87], v[164:179]
  ds_read_b64_tr_b16 v[52:53], v14 offset:4096
  ds_read_b64_tr_b16 v[54:55], v14 offset:4608
  v_mfma_f32_32x32x16_bf16 v[148:163], v[100:103], v[92:95], v[148:163]
  ds_read_b128 v[44:47], v12 offset:0
  ds_read_b128 v[48:51], v12 offset:4096
  v_mfma_f32_32x32x16_bf16 v[164:179], v[100:103], v[96:99], v[164:179]
  ds_read_b64_tr_b16 v[64:65], v14 offset:6144
  ds_read_b64_tr_b16 v[66:67], v14 offset:6656
  v_mfma_f32_32x32x16_bf16 v[148:163], v[112:115], v[104:107], v[148:163]
  ds_read_b128 v[56:59], v13 offset:0
  s_waitcnt lgkmcnt(12)
  ds_read_b128 v[60:63], v13 offset:4096
  v_mfma_f32_32x32x16_bf16 v[164:179], v[112:115], v[108:111], v[164:179]
  s_cbranch_scc1 P1_loop0
  s_nop 6
  v_cvt_pk_bf16_f32 v148, v148, v149
  v_cvt_pk_bf16_f32 v149, v150, v151
  v_cvt_pk_bf16_f32 v150, v152, v153
  v_cvt_pk_bf16_f32 v151, v154, v155
  buffer_store_dwordx4 v[148:151], v16, s[28:31], s50 offen offset:0 sc1
  v_cvt_pk_bf16_f32 v156, v156, v157
  v_cvt_pk_bf16_f32 v157, v158, v159
  v_cvt_pk_bf16_f32 v158, v160, v161
  v_cvt_pk_bf16_f32 v159, v162, v163
  buffer_store_dwordx4 v[156:159], v16, s[28:31], s51 offen offset:0 sc1
  v_cvt_pk_bf16_f32 v164, v164, v165
  v_cvt_pk_bf16_f32 v165, v166, v167
  v_cvt_pk_bf16_f32 v166, v168, v169
  v_cvt_pk_bf16_f32 v167, v170, v171
  buffer_store_dwordx4 v[164:167], v16, s[28:31], s50 offen offset:1024 sc1
  v_cvt_pk_bf16_f32 v172, v172, v173
  v_cvt_pk_bf16_f32 v173, v174, v175
  v_cvt_pk_bf16_f32 v174, v176, v177
  v_cvt_pk_bf16_f32 v175, v178, v179
  buffer_store_dwordx4 v[172:175], v16, s[28:31], s51 offen offset:1024 sc1
  s_mov_b32 s36, 0
  s_cmp_eq_u32 s56, 0
  s_cbranch_scc1 P1_loop1
P1_loop2:
  s_cmp_lg_u32 s36, 1
  s_cbranch_scc1 P1_loop2_nw
  s_waitcnt vmcnt(0)
P1_loop2_nw:
  s_add_u32 s36, s36, 1
  s_cmp_lg_u32 s36, 4
  s_cselect_b32 s37, s38, s39
  s_waitcnt lgkmcnt(0)
  s_barrier
  v_cndmask_b32 v28, v28, v15, s[56:57]
  v_cndmask_b32 v29, v29, v15, s[56:57]
  v_cndmask_b32 v30, v30, v15, s[56:57]
  v_cndmask_b32 v31, v31, v15, s[56:57]
  ds_read_b64_tr_b16 v[76:77], v14 offset:8192
  ds_read_b64_tr_b16 v[78:79], v14 offset:8704
  v_mfma_f32_32x32x16_bf16 v[116:131], v[20:23], v[28:31], v[116:131]
  v_cndmask_b32 v40, v40, v15, s[56:57]
  v_cndmask_b32 v41, v41, v15, s[56:57]
  v_cndmask_b32 v42, v42, v15, s[56:57]
  v_cndmask_b32 v43, v43, v15, s[56:57]
  ds_read_b128 v[68:71], v10 offset:16384
  ds_read_b128 v[72:75], v10 offset:20480
  v_mfma_f32_32x32x16_bf16 v[132:147], v[24:27], v[28:31], v[132:147]
  ds_read_b64_tr_b16 v[88:89], v14 offset:10240
  ds_read_b64_tr_b16 v[90:91], v14 offset:10752
  v_mfma_f32_32x32x16_bf16 v[116:131], v[32:35], v[40:43], v[116:131]
  v_cndmask_b32 v52, v52, v15, s[56:57]
  v_cndmask_b32 v53, v53, v15, s[56:57]
  v_cndmask_b32 v54, v54, v15, s[56:57]
  v_cndmask_b32 v55, v55, v15, s[56:57]
  ds_read_b128 v[80:83], v11 offset:16384
  ds_read_b128 v[84:87], v11 offset:20480
  v_mfma_f32_32x32x16_bf16 v[132:147], v[36:39], v[40:43], v[132:147]
  ds_read_b64_tr_b16 v[100:101], v14 offset:12288
  ds_read_b64_tr_b16 v[102:103], v14 offset:12800
  v_mfma_f32_32x32x16_bf16 v[116:131], v[44:47], v[52:55], v[116:131]
  v_cndmask_b32 v64, v64, v15, s[56:57]
  v_cndmask_b32 v65, v65, v15, s[56:57]
  v_cndmask_b32 v66, v66, v15, s[56:57]
  v_cndmask_b32 v67, v67, v15, s[56:57]
  ds_read_b128 v[92:95], v12 offset:16384
  ds_read_b128 v[96:99], v12 offset:20480
  v_mfma_f32_32x32x16_bf16 v[132:147], v[48:51], v[52:55], v[132:147]
  ds_read_b64_tr_b16 v[112:113], v14 offset:14336
  ds_read_b64_tr_b16 v[114:115], v14 offset:14848
  v_mfma_f32_32x32x16_bf16 v[116:131], v[56:59], v[64:67], v[116:131]
  ds_read_b128 v[104:107], v13 offset:16384
  s_waitcnt lgkmcnt(12)
  ds_read_b128 v[108:111], v13 offset:20480
  v_mfma_f32_32x32x16_bf16 v[132:147], v[60:63], v[64:67], v[132:147]
  v_add_u32 v10, s37, v10
  v_add_u32 v11, s37, v11
  v_add_u32 v12, s37, v12
  v_add_u32 v13, s37, v13
  v_xor_b32 v14, 0x4000, v14
  s_waitcnt lgkmcnt(0)
  s_cbranch_scc0 P1_loop2_last
  s_barrier
  v_cndmask_b32 v76, v76, v15, s[56:57]
  v_cndmask_b32 v77, v77, v15, s[56:57]
  v_cndmask_b32 v78, v78, v15, s[56:57]
  v_cndmask_b32 v79, v79, v15, s[56:57]
  ds_read_b64_tr_b16 v[28:29], v14 offset:0
  ds_read_b64_tr_b16 v[30:31], v14 offset:512
  v_mfma_f32_32x32x16_bf16 v[116:131], v[68:71], v[76:79], v[116:131]
  v_cndmask_b32 v88, v88, v15, s[56:57]
  v_cndmask_b32 v89, v89, v15, s[56:57]
  v_cndmask_b32 v90, v90, v15, s[56:57]
  v_cndmask_b32 v91, v91, v15, s[56:57]
  ds_read_b128 v[20:23], v10 offset:0
  ds_read_b128 v[24:27], v10 offset:4096
  v_mfma_f32_32x32x16_bf16 v[132:147], v[72:75], v[76:79], v[132:147]
  ds_read_b64_tr_b16 v[40:41], v14 offset:2048
  ds_read_b64_tr_b16 v[42:43], v14 offset:2560
  v_mfma_f32_32x32x16_bf16 v[116:131], v[80:83], v[88:91], v[116:131]
  v_cndmask_b32 v100, v100, v15, s[56:57]
  v_cndmask_b32 v101, v101, v15, s[56:57]
  v_cndmask_b32 v102, v102, v15, s[56:57]
  v_cndmask_b32 v103, v103, v15, s[56:57]
  ds_read_b128 v[32:35], v11 offset:0
  ds_read_b128 v[36:39], v11 offset:4096
  v_mfma_f32_32x32x16_bf16 v[132:147], v[84:87], v[88:91], v[132:147]
  ds_read_b64_tr_b16 v[52:53], v14 offset:4096
  ds_read_b64_tr_b16 v[54:55], v14 offset:4608
  v_mfma_f32_32x32x16_bf16 v[116:131], v[92:95], v[100:103], v[116:131]
  v_cndmask_b32 v112, v112, v15, s[56:57]
  v_cndmask_b32 v113, v113, v15, s[56:57]
  v_cndmask_b32 v114, v114, v15, s[56:57]
  v_cndmask_b32 v115, v115, v15, s[56:57]
  ds_read_b128 v[44:47], v12 offset:0
  ds_read_b128 v[48:51], v12 offset:4096
  v_mfma_f32_32x32x16_bf16 v[132:147], v[96:99], v[100:103], v[132:147]
  ds_read_b64_tr_b16 v[64:65], v14 offset:6144
  ds_read_b64_tr_b16 v[66:67], v14 offset:6656
  v_mfma_f32_32x32x16_bf16 v[116:131], v[104:107], v[112:115], v[116:131]
  ds_read_b128 v[56:59], v13 offset:0
  s_waitcnt lgkmcnt(12)
  ds_read_b128 v[60:63], v13 offset:4096
  v_mfma_f32_32x32x16_bf16 v[132:147], v[108:111], v[112:115], v[132:147]
  s_cmp_lg_u32 s36, s42
  s_cbranch_scc1 Larr11
  s_mov_b64 exec, 1
  buffer_atomic_add v17, v18, s[28:31], s53 offen sc1
  s_mov_b64 exec, -1
Larr11:
  s_branch P1_loop2
P1_loop2_last:
  v_cndmask_b32 v76, v76, v15, s[56:57]
  v_cndmask_b32 v77, v77, v15, s[56:57]
  v_cndmask_b32 v78, v78, v15, s[56:57]
  v_cndmask_b32 v79, v79, v15, s[56:57]
  s_nop 1
  v_mfma_f32_32x32x16_bf16 v[116:131], v[68:71], v[76:79], v[116:131]
  v_cndmask_b32 v88, v88, v15, s[56:57]
  v_cndmask_b32 v89, v89, v15, s[56:57]
  v_cndmask_b32 v90, v90, v15, s[56:57]
  v_cndmask_b32 v91, v91, v15, s[56:57]
  v_mfma_f32_32x32x16_bf16 v[132:147], v[72:75], v[76:79], v[132:147]
  s_nop 0
  v_mfma_f32_32x32x16_bf16 v[116:131], v[80:83], v[88:91], v[116:131]
  v_cndmask_b32 v100, v100, v15, s[56:57]
  v_cndmask_b32 v101, v101, v15, s[56:57]
  v_cndmask_b32 v102, v102, v15, s[56:57]
  v_cndmask_b32 v103, v103, v15, s[56:57]
  v_mfma_f32_32x32x16_bf16 v[132:147], v[84:87], v[88:91], v[132:147]
  s_nop 0
  v_mfma_f32_32x32x16_bf16 v[116:131], v[92:95], v[100:103], v[116:131]
  v_cndmask_b32 v112, v112, v15, s[56:57]
  v_cndmask_b32 v113, v113, v15, s[56:57]
  v_cndmask_b32 v114, v114, v15, s[56:57]
  v_cndmask_b32 v115, v115, v15, s[56:57]
  v_mfma_f32_32x32x16_bf16 v[132:147], v[96:99], v[100:103], v[132:147]
  s_nop 0
  v_mfma_f32_32x32x16_bf16 v[116:131], v[104:107], v[112:115], v[116:131]
  v_mfma_f32_32x32x16_bf16 v[132:147], v[108:111], v[112:115], v[132:147]
  s_branch P1_epiA
P1_loop1:
  s_cmp_lg_u32 s36, 1
  s_cbranch_scc1 P1_loop1_nw
  s_waitcnt vmcnt(0)
P1_loop1_nw:
  s_add_u32 s36, s36, 1
  s_cmp_lg_u32 s36, 4
  s_cselect_b32 s37, s38, s39
  s_waitcnt lgkmcnt(0)
  s_barrier
  ds_read_b64_tr_b16 v[76:77], v14 offset:8192
  ds_read_b64_tr_b16 v[78:79], v14 offset:8704
  v_mfma_f32_32x32x16_bf16 v[116:131], v[20:23], v[28:31], v[116:131]
  ds_read_b128 v[68:71], v10 offset:16384
  ds_read_b128 v[72:75], v10 offset:20480
  v_mfma_f32_32x32x16_bf16 v[132:147], v[24:27], v[28:31], v[132:147]
  ds_read_b64_tr_b16 v[88:89], v14 offset:10240
  ds_read_b64_tr_b16 v[90:91], v14 offset:10752
  v_mfma_f32_32x32x16_bf16 v[116:131], v[32:35], v[40:43], v[116:131]
  ds_read_b128 v[80:83], v11 offset:16384
  ds_read_b128 v[84:87], v11 offset:20480
  v_mfma_f32_32x32x16_bf16 v[132:147], v[36:39], v[40:43], v[132:147]
  ds_read_b64_tr_b16 v[100:101], v14 offset:12288
  ds_read_b64_tr_b16 v[102:103], v14 offset:12800
  v_mfma_f32_32x32x16_bf16 v[116:131], v[44:47], v[52:55], v[116:131]
  ds_read_b128 v[92:95], v12 offset:16384
  ds_read_b128 v[96:99], v12 offset:20480
  v_mfma_f32_32x32x16_bf16 v[132:147], v[48:51], v[52:55], v[132:147]
  ds_read_b64_tr_b16 v[112:113], v14 offset:14336
  ds_read_b64_tr_b16 v[114:115], v14 offset:14848
  v_mfma_f32_32x32x16_bf16 v[116:131], v[56:59], v[64:67], v[116:131]
  ds_read_b128 v[104:107], v13 offset:16384
  s_waitcnt lgkmcnt(12)
  ds_read_b128 v[108:111], v13 offset:20480
  v_mfma_f32_32x32x16_bf16 v[132:147], v[60:63], v[64:67], v[132:147]
  v_add_u32 v10, s37, v10
  v_add_u32 v11, s37, v11
  v_add_u32 v12, s37, v12
  v_add_u32 v13, s37, v13
  v_xor_b32 v14, 0x4000, v14
  s_waitcnt lgkmcnt(0)
  s_cbranch_scc0 P1_loop1_last
  s_barrier
  ds_read_b64_tr_b16 v[28:29], v14 offset:0
  ds_read_b64_tr_b16 v[30:31], v14 offset:512
  v_mfma_f32_32x32x16_bf16 v[116:131], v[68:71], v[76:79], v[116:131]
  ds_read_b128 v[20:23], v10 offset:0
  ds_read_b128 v[24:27], v10 offset:4096
  v_mfma_f32_32x32x16_bf16 v[132:147], v[72:75], v[76:79], v[132:147]
  ds_read_b64_tr_b16 v[40:41], v14 offset:2048
  ds_read_b64_tr_b16 v[42:43], v14 offset:2560
  v_mfma_f32_32x32x16_bf16 v[116:131], v[80:83], v[88:91], v[116:131]
  ds_read_b128 v[32:35], v11 offset:0
  ds_read_b128 v[36:39], v11 offset:4096
  v_mfma_f32_32x32x16_bf16 v[132:147], v[84:87], v[88:91], v[132:147]
  ds_read_b64_tr_b16 v[52:53], v14 offset:4096
  ds_read_b64_tr_b16 v[54:55], v14 offset:4608
  v_mfma_f32_32x32x16_bf16 v[116:131], v[92:95], v[100:103], v[116:131]
  ds_read_b128 v[44:47], v12 offset:0
  ds_read_b128 v[48:51], v12 offset:4096
  v_mfma_f32_32x32x16_bf16 v[132:147], v[96:99], v[100:103], v[132:147]
  ds_read_b64_tr_b16 v[64:65], v14 offset:6144
  ds_read_b64_tr_b16 v[66:67], v14 offset:6656
  v_mfma_f32_32x32x16_bf16 v[116:131], v[104:107], v[112:115], v[116:131]
  ds_read_b128 v[56:59], v13 offset:0
  s_waitcnt lgkmcnt(12)
  ds_read_b128 v[60:63], v13 offset:4096
  v_mfma_f32_32x32x16_bf16 v[132:147], v[108:111], v[112:115], v[132:147]
  s_cmp_lg_u32 s36, s42
  s_cbranch_scc1 Larr12
  s_mov_b64 exec, 1
  buffer_atomic_add v17, v18, s[28:31], s53 offen sc1
  s_mov_b64 exec, -1
Larr12:
  s_branch P1_loop1
P1_loop1_last:
  v_mfma_f32_32x32x16_bf16 v[116:131], v[68:71], v[76:79], v[116:131]
  v_mfma_f32_32x32x16_bf16 v[132:147], v[72:75], v[76:79], v[132:147]
  v_mfma_f32_32x32x16_bf16 v[116:131], v[80:83], v[88:91], v[116:131]
  v_mfma_f32_32x32x16_bf16 v[132:147], v[84:87], v[88:91], v[132:147]
  v_mfma_f32_32x32x16_bf16 v[116:131], v[92:95], v[100:103], v[116:131]
  v_mfma_f32_32x32x16_bf16 v[132:147], v[96:99], v[100:103], v[132:147]
  v_mfma_f32_32x32x16_bf16 v[116:131], v[104:107], v[112:115], v[116:131]
  v_mfma_f32_32x32x16_bf16 v[132:147], v[108:111], v[112:115], v[132:147]
  s_cmp_lg_u32 s3, 0
  s_cbranch_scc1 P1_epiA
  v_and_b32 v4, 15, v0
  v_lshlrev_b32 v4, 4, v4
  v_lshl_add_u32 v4, v8, 8, v4
  v_lshrrev_b32 v5, 4, v7
  v_lshl_add_u32 v4, v5, 16, v4
  v_add_u32 v16, s47, v4
  s_lshl_b32 s50, s22, 18
  s_add_u32 s50, s50, s48
  s_add_u32 s50, s50, 0x400000
  v_cvt_pk_bf16_f32 v116, v116, v117
  v_cvt_pk_bf16_f32 v117, v118, v119
  v_cvt_pk_bf16_f32 v118, v120, v121
  v_cvt_pk_bf16_f32 v119, v122, v123
  buffer_store_dwordx4 v[116:119], v16, s[28:31], s50 offen offset:0 sc1
  v_cvt_pk_bf16_f32 v124, v124, v125
  v_cvt_pk_bf16_f32 v125, v126, v127
  v_cvt_pk_bf16_f32 v126, v128, v129
  v_cvt_pk_bf16_f32 v127, v130, v131
  buffer_store_dwordx4 v[124:127], v16, s[28:31], s50 offen offset:512 sc1
  v_cvt_pk_bf16_f32 v132, v132, v133
  v_cvt_pk_bf16_f32 v133, v134, v135
  v_cvt_pk_bf16_f32 v134, v136, v137
  v_cvt_pk_bf16_f32 v135, v138, v139
  buffer_store_dwordx4 v[132:135], v16, s[28:31], s50 offen offset:1024 sc1
  v_cvt_pk_bf16_f32 v140, v140, v141
  v_cvt_pk_bf16_f32 v141, v142, v143
  v_cvt_pk_bf16_f32 v142, v144, v145
  v_cvt_pk_bf16_f32 v143, v146, v147
  buffer_store_dwordx4 v[140:143], v16, s[28:31], s50 offen offset:1536 sc1
  s_waitcnt vmcnt(0)
  s_add_u32 s52, s52, 0x8000
  s_mov_b64 exec, 1
  buffer_store_dword v17, v18, s[28:31], s52 offen sc1
  s_mov_b64 exec, -1
  s_branch P2_c
P1_epiA:
  s_lshl_b32 s47, s21, 10
  s_lshl_b32 s48, s45, 9
  s_add_u32 s47, s47, s48
  s_lshl_b32 s48, s46, 20
  s_add_u32 s47, s47, s48
  s_lshl_b32 s48, s20, 13
  s_add_u32 s47, s47, s48
  s_add_u32 s47, s47, 0x600000
  v_lshlrev_b32 v4, 18, v8
  v_lshl_add_u32 v4, v9, 4, v4
  v_add_u32 v164, s47, v4
  s_lshl_b32 s47, s16, 11
  s_add_u32 s47, s47, 0x10000
  v_lshl_add_u32 v4, v0, 4, s47
  v_xor_b32 v165, 0x1000, v4
  v_cvt_pk_bf16_f32 v52, v116, v117
  v_cvt_pk_bf16_f32 v53, v118, v119
  v_cvt_pk_bf16_f32 v54, v120, v121
  v_cvt_pk_bf16_f32 v55, v122, v123
  v_cvt_pk_bf16_f32 v56, v124, v125
  v_cvt_pk_bf16_f32 v57, v126, v127
  v_cvt_pk_bf16_f32 v58, v128, v129
  v_cvt_pk_bf16_f32 v59, v130, v131
  v_mfma_f32_32x32x16_bf16 v[20:35], v[180:183], v[52:55], 0
  s_nop 0
  v_mfma_f32_32x32x16_bf16 v[20:35], v[184:187], v[56:59], v[20:35]
  v_cvt_pk_bf16_f32 v60, v132, v133
  v_cvt_pk_bf16_f32 v61, v134, v135
  v_cvt_pk_bf16_f32 v62, v136, v137
  v_cvt_pk_bf16_f32 v63, v138, v139
  v_cvt_pk_bf16_f32 v64, v140, v141
  v_cvt_pk_bf16_f32 v65, v142, v143
  v_cvt_pk_bf16_f32 v66, v144, v145
  v_cvt_pk_bf16_f32 v67, v146, v147
  v_mfma_f32_32x32x16_bf16 v[36:51], v[180:183], v[60:63], 0
  s_nop 0
  v_mfma_f32_32x32x16_bf16 v[36:51], v[184:187], v[64:67], v[36:51]
  s_nop 11
  v_cvt_pk_bf16_f32 v52, v28, v44
  v_cvt_pk_bf16_f32 v53, v29, v45
  v_cvt_pk_bf16_f32 v54, v30, v46
  v_cvt_pk_bf16_f32 v55, v31, v47
  v_cvt_pk_bf16_f32 v56, v32, v48
  v_cvt_pk_bf16_f32 v57, v33, v49
  v_cvt_pk_bf16_f32 v58, v34, v50
  v_cvt_pk_bf16_f32 v59, v35, v51
  ds_write_b128 v4, v[52:55]
  ds_write_b128 v4, v[56:59] offset:1024
  v_cvt_pk_bf16_f32 v148, v20, v36
  v_cvt_pk_bf16_f32 v149, v21, v37
  v_cvt_pk_bf16_f32 v152, v22, v38
  v_cvt_pk_bf16_f32 v153, v23, v39
  v_cvt_pk_bf16_f32 v156, v24, v40
  v_cvt_pk_bf16_f32 v157, v25, v41
  v_cvt_pk_bf16_f32 v160, v26, v42
  v_cvt_pk_bf16_f32 v161, v27, v43
P2_c:
  s_and_b32 s16, s2, 7
  s_lshl_b32 s17, s16, 2
  s_bfe_u32 s18, s2, 0x20003
  s_or_b32 s17, s17, s18
  s_lshr_b32 s19, s2, 5
  s_lshl_b32 s32, s17, 16
  s_lshl_b32 s33, s19, 1
  s_branch P2_nl
P2_start:
  s_and_b32 s16, s2, 7
  s_lshl_b32 s17, s16, 2
  s_bfe_u32 s18, s2, 0x20003
  s_or_b32 s17, s17, s18
  s_lshr_b32 s19, s2, 5
  s_lshl_b32 s32, s17, 16
  s_lshl_b32 s33, s19, 1
  s_and_b32 s34, s54, 3
  s_add_u32 s35, s33, s34
  s_sub_u32 s36, s35, 2
  s_cselect_b32 s35, s35, s36
  s_lshr_b32 s36, s34, 1
  s_add_u32 s36, s36, s33
  s_lshr_b32 s37, s16, 2
  s_lshl_b32 s37, s37, 1
  s_and_b32 s38, s16, 3
  s_lshl_b32 s38, s38, 6
  s_lshr_b32 s39, s36, 3
  s_and_b32 s46, s36, 7
  s_lshl_b32 s46, s46, 3
  s_or_b32 s46, s46, s39
  s_or_b32 s46, s46, s37
  s_or_b32 s46, s46, s38
  s_add_u32 s37, s37, 4
  s_lshr_b32 s39, s35, 3
  s_and_b32 s47, s35, 7
  s_lshl_b32 s47, s47, 3
  s_or_b32 s47, s47, s39
  s_or_b32 s47, s47, s37
  s_or_b32 s47, s47, s38
  s_lshl_b32 s46, s46, 7
  s_lshl_b32 s47, s47, 7
  v_mov_b32 v2, s46
  v_writelane_b32 v2, s47, 1
  s_lshl_b32 s35, s35, 12
  s_add_u32 s35, s35, s32
  s_add_u32 s35, s35, 0x200000
  s_lshl_b32 s36, s19, 13
  s_add_u32 s36, s36, s32
  s_lshl_b32 s37, s34, 11
  s_add_u32 s36, s36, s37
  s_mov_b32 s47, 0xa40000
  s_mov_b64 exec, 3
  buffer_load_dword v4, v2, s[28:31], s47 offen sc1
P2_kq:
  s_mov_b64 exec, 3
  s_waitcnt vmcnt(0)
  s_mov_b32 s48, 0
  s_branch Lpoll13c
Lpoll13:
Lpoll13l:
  buffer_load_dword v4, v2, s[28:31], s47 offen sc1
  s_waitcnt vmcnt(0)
Lpoll13c:
  v_cmp_gt_u32 vcc, 1, v4
  s_add_u32 s48, s48, 1
  s_cmp_ge_u32 s48, 65536
  s_cbranch_scc1 Lpoll13x
  s_and_b64 exec, exec, vcc
  s_cbranch_scc1 Lpoll13
Lpoll13x:
  s_mov_b64 exec, -1
  s_lshl_b32 m0, s34, 12
  s_nop 0
  buffer_load_dwordx4 v251, s[28:31], s35 offen offset:0 sc1 lds
  buffer_load_dwordx4 v251, s[28:31], s35 offen offset:1024 sc1 lds
  buffer_load_dwordx4 v251, s[28:31], s35 offen offset:2048 sc1 lds
  buffer_load_dwordx4 v251, s[28:31], s35 offen offset:3072 sc1 lds
  s_add_u32 m0, s37, 0xe000
  s_nop 0
  buffer_load_dwordx4 v251, s[28:31], s36 offen offset:0 sc1 lds
  buffer_load_dwordx4 v251, s[28:31], s36 offen offset:1024 sc1 lds
  s_mov_b32 s46, 0x3f803f80
  v_mov_b32 v2, s46
  v_mov_b32 v3, s46
  v_mov_b32 v4, s46
  v_mov_b32 v5, s46
  s_lshl_b32 s46, s34, 12
  v_add_u32 v6, s46, v251
  ds_write_b128 v6, v[2:5] offset:0x8000
  ds_write_b128 v6, v[2:5] offset:0x8400
  ds_write_b128 v6, v[2:5] offset:0x8800
  ds_write_b128 v6, v[2:5] offset:0x8c00
P2_nl:
  s_lshl_b32 s18, s19, 3
  s_add_u32 s18, s18, s54
  s_cmp_eq_u32 s19, 0
  s_cselect_b32 s55, 0xff800000, 0
  s_and_b32 s34, s54, 3
  s_add_u32 s35, s33, s34
  s_sub_u32 s36, s35, 2
  s_cselect_b32 s35, s35, s36
  s_and_b32 s37, s16, 6
  s_and_b32 s38, s16, 1
  s_lshl_b32 s38, s38, 6
  s_lshr_b32 s39, s35, 3
  s_and_b32 s46, s35, 7
  s_lshl_b32 s46, s46, 3
  s_or_b32 s46, s46, s39
  s_or_b32 s46, s46, s37
  s_or_b32 s46, s46, s38
  s_lshl_b32 s46, s46, 7
  s_and_b32 s37, s17, 2
  s_lshl_b32 s37, s37, 2
  s_add_u32 s46, s46, s37
  s_add_u32 s46, s46, 0xa4c000
  v_mov_b32 v246, s46
  s_lshl_b32 s35, s35, 12
  s_add_u32 s35, s35, s32
  s_add_u32 s35, s35, 0x400000
  s_lshl_b32 s36, s34, 12
  s_mov_b32 s53, 0
  s_mov_b32 s46, 0x3eb8aa3b
  s_cmp_lt_u32 s54, 4
  s_cbranch_scc1 P2_b1
  s_waitcnt vmcnt(0)
P2_b1:
  s_waitcnt lgkmcnt(0)
  s_barrier
  ds_read_b128 v[44:47], v253 offset:0xe000
  ds_read_b128 v[8:11], v253 offset:8192
  ds_read_b128 v[40:43], v253 offset:0
  ds_read_b128 v[12:15], v253 offset:7168
  ds_read_b128 v[16:19], v253 offset:6144
  ds_read_b128 v[20:23], v253 offset:5120
  ds_read_b128 v[24:27], v253 offset:4096
  ds_read_b128 v[28:31], v253 offset:3072
  ds_read_b128 v[32:35], v253 offset:2048
  ds_read_b128 v[36:39], v253 offset:1024
  s_cmp_ge_u32 s54, 4
  s_cbranch_scc1 P2_pd
  s_mov_b64 exec, 1
  buffer_load_dwordx2 v[240:241], v246, s[28:31], 0 offen sc1
  s_mov_b64 exec, -1
  s_cmp_eq_u32 s3, 0
  s_cbranch_scc1 P2_pd
  ds_read_b64 v[150:151], v165 offset:0
  ds_read_b64 v[154:155], v165 offset:8
  ds_read_b64 v[158:159], v165 offset:1024
  ds_read_b64 v[162:163], v165 offset:1032
  s_mov_b32 s47, 0x20000
  s_mov_b32 s48, 0x80000
  s_mov_b32 s49, 0xa0000
  s_waitcnt lgkmcnt(0)
  buffer_store_dwordx4 v[148:151], v164, s[28:31], 0 offen sc1
  buffer_store_dwordx4 v[152:155], v164, s[28:31], s47 offen sc1
  buffer_store_dwordx4 v[156:159], v164, s[28:31], s48 offen sc1
  buffer_store_dwordx4 v[160:163], v164, s[28:31], s49 offen sc1
P2_pd:
  s_waitcnt lgkmcnt(9)
  v_lshlrev_b32 v2, 16, v44
  v_and_b32 v3, 0xffff0000, v44
  v_pk_mul_f32 v[2:3], v[2:3], s[46:47] op_sel_hi:[1,0]
  v_cvt_pk_bf16_f32 v44, v2, v3
  v_lshlrev_b32 v2, 16, v45
  v_and_b32 v3, 0xffff0000, v45
  v_pk_mul_f32 v[2:3], v[2:3], s[46:47] op_sel_hi:[1,0]
  v_cvt_pk_bf16_f32 v45, v2, v3
  v_lshlrev_b32 v2, 16, v46
  v_and_b32 v3, 0xffff0000, v46
  v_pk_mul_f32 v[2:3], v[2:3], s[46:47] op_sel_hi:[1,0]
  v_cvt_pk_bf16_f32 v46, v2, v3
  v_lshlrev_b32 v2, 16, v47
  v_and_b32 v3, 0xffff0000, v47
  v_pk_mul_f32 v[2:3], v[2:3], s[46:47] op_sel_hi:[1,0]
  v_cvt_pk_bf16_f32 v47, v2, v3
  s_waitcnt lgkmcnt(7)
  s_nop 0
  v_mfma_f32_32x32x16_bf16 v[48:63], v[8:11], v[44:47], 0
  v_mfma_f32_32x32x16_bf16 v[64:79], v[40:43], v[44:47], v[216:231]
  s_mov_b32 m0, s1
  s_nop 0
  buffer_load_dwordx4 v244, s[96:99], s0 offen offset:0 lds
  s_add_u32 s0, s0, 7168
  s_nop 7
  v_cndmask_b32 v48, v64, v48, s[64:65]
  v_cndmask_b32 v49, v65, v49, s[66:67]
  v_cndmask_b32 v50, v66, v50, s[68:69]
  v_cndmask_b32 v51, v67, v51, s[70:71]
  v_cndmask_b32 v52, v68, v52, s[72:73]
  v_cndmask_b32 v53, v69, v53, s[74:75]
  v_cndmask_b32 v54, v70, v54, s[76:77]
  v_cndmask_b32 v55, v71, v55, s[78:79]
  v_cndmask_b32 v56, v72, v56, s[80:81]
  v_cndmask_b32 v57, v73, v57, s[82:83]
  v_cndmask_b32 v58, v74, v58, s[84:85]
  v_cndmask_b32 v59, v75, v59, s[86:87]
  v_cndmask_b32 v60, v76, v60, s[88:89]
  v_cndmask_b32 v61, v77, v61, s[90:91]
  v_cndmask_b32 v62, v78, v62, s[92:93]
  v_cndmask_b32 v63, v79, v63, s[94:95]
  v_max3_f32 v248, v48, v49, v50
  v_max3_f32 v248, v248, v51, v52
  v_max3_f32 v248, v248, v53, v54
  v_max3_f32 v248, v248, v55, v56
  v_max3_f32 v248, v248, v57, v58
  v_max3_f32 v248, v248, v59, v60
  v_max3_f32 v248, v248, v61, v62
  v_max_f32 v248, v248, v63
  v_mov_b32 v1, v248
  s_nop 1
  v_permlane32_swap_b32 v1, v248
  v_max_f32 v248, v1, v248
  v_pk_add_f32 v[216:217], 0, v[248:249] op_sel:[0,0] op_sel_hi:[1,0] neg_lo:[0,1] neg_hi:[0,1]
  v_pk_add_f32 v[218:219], 0, v[248:249] op_sel:[0,0] op_sel_hi:[1,0] neg_lo:[0,1] neg_hi:[0,1]
  v_pk_add_f32 v[220:221], 0, v[248:249] op_sel:[0,0] op_sel_hi:[1,0] neg_lo:[0,1] neg_hi:[0,1]
  v_pk_add_f32 v[222:223], 0, v[248:249] op_sel:[0,0] op_sel_hi:[1,0] neg_lo:[0,1] neg_hi:[0,1]
  v_pk_add_f32 v[224:225], 0, v[248:249] op_sel:[0,0] op_sel_hi:[1,0] neg_lo:[0,1] neg_hi:[0,1]
  v_pk_add_f32 v[226:227], 0, v[248:249] op_sel:[0,0] op_sel_hi:[1,0] neg_lo:[0,1] neg_hi:[0,1]
  v_pk_add_f32 v[228:229], 0, v[248:249] op_sel:[0,0] op_sel_hi:[1,0] neg_lo:[0,1] neg_hi:[0,1]
  v_pk_add_f32 v[230:231], 0, v[248:249] op_sel:[0,0] op_sel_hi:[1,0] neg_lo:[0,1] neg_hi:[0,1]
  s_waitcnt lgkmcnt(0)
  s_cmp_eq_u32 s18, 0
  s_cbranch_scc1 P2_ob1
P2_zb1:
  v_mfma_f32_32x32x16_bf16 v[80:95], v[12:15], v[44:47], v[216:231]
  s_cmp_eq_u32 s18, 1
  s_cbranch_scc1 P2_ob2
P2_zb2:
  v_mfma_f32_32x32x16_bf16 v[96:111], v[16:19], v[44:47], v[216:231]
  buffer_load_dwordx4 v244, s[96:99], s0 offen offset:1024 lds
  s_add_u32 s0, s0, 7168
  v_pk_add_f32 v[48:49], v[48:49], v[248:249] op_sel:[0,0] op_sel_hi:[1,0] neg_lo:[0,1] neg_hi:[0,1]
  v_pk_add_f32 v[50:51], v[50:51], v[248:249] op_sel:[0,0] op_sel_hi:[1,0] neg_lo:[0,1] neg_hi:[0,1]
  v_pk_add_f32 v[52:53], v[52:53], v[248:249] op_sel:[0,0] op_sel_hi:[1,0] neg_lo:[0,1] neg_hi:[0,1]
  v_pk_add_f32 v[54:55], v[54:55], v[248:249] op_sel:[0,0] op_sel_hi:[1,0] neg_lo:[0,1] neg_hi:[0,1]
  v_pk_add_f32 v[56:57], v[56:57], v[248:249] op_sel:[0,0] op_sel_hi:[1,0] neg_lo:[0,1] neg_hi:[0,1]
  v_pk_add_f32 v[58:59], v[58:59], v[248:249] op_sel:[0,0] op_sel_hi:[1,0] neg_lo:[0,1] neg_hi:[0,1]
  v_pk_add_f32 v[60:61], v[60:61], v[248:249] op_sel:[0,0] op_sel_hi:[1,0] neg_lo:[0,1] neg_hi:[0,1]
  v_pk_add_f32 v[62:63], v[62:63], v[248:249] op_sel:[0,0] op_sel_hi:[1,0] neg_lo:[0,1] neg_hi:[0,1]
  buffer_load_dwordx4 v244, s[96:99], s0 offen offset:2048 lds
  s_add_u32 s0, s0, 7168
  v_exp_f32 v48, v48
  v_exp_f32 v49, v49
  v_exp_f32 v50, v50
  v_exp_f32 v51, v51
  v_exp_f32 v52, v52
  v_exp_f32 v53, v53
  v_exp_f32 v54, v54
  v_exp_f32 v55, v55
  v_exp_f32 v56, v56
  v_exp_f32 v57, v57
  v_exp_f32 v58, v58
  v_exp_f32 v59, v59
  v_exp_f32 v60, v60
  v_exp_f32 v61, v61
  v_exp_f32 v62, v62
  v_exp_f32 v63, v63
  buffer_load_dwordx4 v244, s[96:99], s0 offen offset:3072 lds
  s_add_u32 s0, s0, 11264
  v_cvt_pk_bf16_f32 v136, v48, v49
  v_cvt_pk_bf16_f32 v137, v50, v51
  v_cvt_pk_bf16_f32 v138, v52, v53
  v_cvt_pk_bf16_f32 v139, v54, v55
  v_cvt_pk_bf16_f32 v140, v56, v57
  v_cvt_pk_bf16_f32 v141, v58, v59
  v_cvt_pk_bf16_f32 v142, v60, v61
  v_cvt_pk_bf16_f32 v143, v62, v63
  v_and_b32 v128, v136, v232
  v_and_b32 v129, v137, v233
  v_and_b32 v130, v138, v234
  v_and_b32 v131, v139, v235
  v_and_b32 v132, v140, v236
  v_and_b32 v133, v141, v237
  v_and_b32 v134, v142, v238
  v_and_b32 v135, v143, v239
  v_xor_b32 v136, v136, v128
  v_xor_b32 v137, v137, v129
  v_xor_b32 v138, v138, v130
  v_xor_b32 v139, v139, v131
  v_xor_b32 v140, v140, v132
  v_xor_b32 v141, v141, v133
  v_xor_b32 v142, v142, v134
  v_xor_b32 v143, v143, v135
  v_exp_f32 v80, v80
  v_exp_f32 v81, v81
  v_exp_f32 v82, v82
  v_exp_f32 v83, v83
  v_exp_f32 v84, v84
  v_exp_f32 v85, v85
  v_exp_f32 v86, v86
  v_exp_f32 v87, v87
  v_cvt_pk_bf16_f32 v144, v80, v81
  v_cvt_pk_bf16_f32 v145, v82, v83
  v_cvt_pk_bf16_f32 v146, v84, v85
  v_cvt_pk_bf16_f32 v147, v86, v87
  v_exp_f32 v88, v88
  v_exp_f32 v89, v89
  v_exp_f32 v90, v90
  v_exp_f32 v91, v91
  v_exp_f32 v92, v92
  v_exp_f32 v93, v93
  v_exp_f32 v94, v94
  v_exp_f32 v95, v95
  v_cvt_pk_bf16_f32 v148, v88, v89
  v_cvt_pk_bf16_f32 v149, v90, v91
  v_cvt_pk_bf16_f32 v150, v92, v93
  v_cvt_pk_bf16_f32 v151, v94, v95
  s_cmp_eq_u32 s18, 2
  s_cbranch_scc1 P2_ob3
P2_zb3:
  v_mfma_f32_32x32x16_bf16 v[64:79], v[20:23], v[44:47], v[216:231]
  s_cmp_ge_u32 s54, 4
  s_cbranch_scc1 P2_nv
  s_cmp_lg_u32 s3, 0
  s_cbranch_scc1 P2_v8
  s_waitcnt vmcnt(4)
P2_v8:
  s_waitcnt vmcnt(8)
  s_mov_b64 exec, 1
  s_mov_b32 s48, 0
  s_branch Lpoll14c
Lpoll14:
Lpoll14l:
  buffer_load_dwordx2 v[240:241], v246, s[28:31], 0 offen sc1
  s_waitcnt vmcnt(0)
Lpoll14c:
  v_and_b32 v240, v240, v241
  v_cmp_gt_u32 vcc, 1, v240
  s_add_u32 s48, s48, 1
  s_cmp_ge_u32 s48, 65536
  s_cbranch_scc1 Lpoll14x
  s_and_b64 exec, exec, vcc
  s_cbranch_scc1 Lpoll14
Lpoll14x:
  s_mov_b64 exec, -1
  s_add_u32 m0, s36, 0x4000
  s_nop 0
  buffer_load_dwordx4 v251, s[28:31], s35 offen offset:0 sc1 lds
  buffer_load_dwordx4 v251, s[28:31], s35 offen offset:1024 sc1 lds
  buffer_load_dwordx4 v251, s[28:31], s35 offen offset:2048 sc1 lds
  buffer_load_dwordx4 v251, s[28:31], s35 offen offset:3072 sc1 lds
P2_nv:
  v_exp_f32 v96, v96
  v_exp_f32 v97, v97
  v_exp_f32 v98, v98
  v_exp_f32 v99, v99
  v_exp_f32 v100, v100
  v_exp_f32 v101, v101
  v_exp_f32 v102, v102
  v_exp_f32 v103, v103
  v_cvt_pk_bf16_f32 v152, v96, v97
  v_cvt_pk_bf16_f32 v153, v98, v99
  v_cvt_pk_bf16_f32 v154, v100, v101
  v_cvt_pk_bf16_f32 v155, v102, v103
  s_add_u32 m0, s1, 0x1000
  s_nop 0
  buffer_load_dwordx4 v244, s[96:99], s0 offen offset:0 lds
  s_add_u32 s0, s0, 7168
  v_exp_f32 v104, v104
  v_exp_f32 v105, v105
  v_exp_f32 v106, v106
  v_exp_f32 v107, v107
  v_exp_f32 v108, v108
  v_exp_f32 v109, v109
  v_exp_f32 v110, v110
  v_exp_f32 v111, v111
  v_cvt_pk_bf16_f32 v156, v104, v105
  v_cvt_pk_bf16_f32 v157, v106, v107
  v_cvt_pk_bf16_f32 v158, v108, v109
  v_cvt_pk_bf16_f32 v159, v110, v111
  buffer_load_dwordx4 v244, s[96:99], s0 offen offset:1024 lds
  s_add_u32 s0, s0, 7168
  s_cmp_eq_u32 s18, 3
  s_cbranch_scc1 P2_ob4
P2_zb4:
  v_mfma_f32_32x32x16_bf16 v[80:95], v[24:27], v[44:47], v[216:231]
  s_lshr_b32 s47, s54, 2
  s_andn2_b32 s47, s3, s47
  s_cbranch_scc0 P2_nc
  v_mov_b32 v1, 1
  s_lshl_b32 s47, s2, 5
  s_add_u32 s47, s47, s54
  s_lshl_b32 s47, s47, 2
  s_add_u32 s47, s47, 0xa48000
  s_waitcnt vmcnt(10)
  s_mov_b64 exec, 1
  buffer_store_dword v1, v251, s[28:31], s47 offen sc1
  s_mov_b64 exec, -1
P2_nc:
  s_cmp_lg_u32 s54, 7
  s_cbranch_scc1 P2_nd
  buffer_load_dword v241, v255, s[28:31], 0 offen sc1
P2_nd:
  v_exp_f32 v64, v64
  v_exp_f32 v65, v65
  v_exp_f32 v66, v66
  v_exp_f32 v67, v67
  v_exp_f32 v68, v68
  v_exp_f32 v69, v69
  v_exp_f32 v70, v70
  v_exp_f32 v71, v71
  v_cvt_pk_bf16_f32 v160, v64, v65
  v_cvt_pk_bf16_f32 v161, v66, v67
  v_cvt_pk_bf16_f32 v162, v68, v69
  v_cvt_pk_bf16_f32 v163, v70, v71
  buffer_load_dwordx4 v244, s[96:99], s0 offen offset:2048 lds
  s_add_u32 s0, s0, 7168
  v_exp_f32 v72, v72
  v_exp_f32 v73, v73
  v_exp_f32 v74, v74
  v_exp_f32 v75, v75
  v_exp_f32 v76, v76
  v_exp_f32 v77, v77
  v_exp_f32 v78, v78
  v_exp_f32 v79, v79
  v_cvt_pk_bf16_f32 v164, v72, v73
  v_cvt_pk_bf16_f32 v165, v74, v75
  v_cvt_pk_bf16_f32 v166, v76, v77
  v_cvt_pk_bf16_f32 v167, v78, v79
  buffer_load_dwordx4 v244, s[96:99], s0 offen offset:3072 lds
  s_cmp_eq_u32 s18, 4
  s_cbranch_scc1 P2_ob5
P2_zb5:
  v_mfma_f32_32x32x16_bf16 v[96:111], v[28:31], v[44:47], v[216:231]
  v_exp_f32 v80, v80
  v_exp_f32 v81, v81
  v_exp_f32 v82, v82
  v_exp_f32 v83, v83
  v_exp_f32 v84, v84
  v_exp_f32 v85, v85
  v_exp_f32 v86, v86
  v_exp_f32 v87, v87
  v_cvt_pk_bf16_f32 v168, v80, v81
  v_cvt_pk_bf16_f32 v169, v82, v83
  v_cvt_pk_bf16_f32 v170, v84, v85
  v_cvt_pk_bf16_f32 v171, v86, v87
  v_exp_f32 v88, v88
  v_exp_f32 v89, v89
  v_exp_f32 v90, v90
  v_exp_f32 v91, v91
  v_exp_f32 v92, v92
  v_exp_f32 v93, v93
  v_exp_f32 v94, v94
  v_exp_f32 v95, v95
  v_cvt_pk_bf16_f32 v172, v88, v89
  v_cvt_pk_bf16_f32 v173, v90, v91
  v_cvt_pk_bf16_f32 v174, v92, v93
  v_cvt_pk_bf16_f32 v175, v94, v95
  s_cmp_eq_u32 s18, 5
  s_cbranch_scc1 P2_ob6
P2_zb6:
  v_mfma_f32_32x32x16_bf16 v[64:79], v[32:35], v[44:47], v[216:231]
  s_cmp_ge_u32 s54, 4
  s_cbranch_scc1 P2_n7
  s_waitcnt vmcnt(5)
  s_cmp_lg_u32 s3, 0
  s_cbranch_scc1 P2_nb
  s_waitcnt vmcnt(4)
  s_branch P2_nb
P2_n7:
  s_waitcnt vmcnt(8)
  s_cmp_lg_u32 s54, 7
  s_cbranch_scc1 P2_nb
  s_waitcnt vmcnt(0)
  s_mov_b32 s48, 0
  s_branch Lpoll15c
Lpoll15:
  s_sleep 8
Lpoll15l:
  buffer_load_dword v241, v255, s[28:31], 0 offen sc1
  s_waitcnt vmcnt(0)
Lpoll15c:
  v_cmp_gt_u32 vcc, 32, v241
  s_add_u32 s48, s48, 1
  s_cmp_ge_u32 s48, 65536
  s_cbranch_scc1 Lpoll15x
  s_and_b64 exec, exec, vcc
  s_cbranch_scc1 Lpoll15
Lpoll15x:
  s_mov_b64 exec, -1
P2_nb:
  s_barrier
  ds_read_b128 v[8:11], v254 offset:24576
  ds_read_b128 v[12:15], v254 offset:25088
  ds_read_b128 v[16:19], v254 offset:16384
  ds_read_b128 v[20:23], v254 offset:16896
  ds_read_b128 v[48:51], v254 offset:23552
  ds_read_b128 v[52:55], v254 offset:24064
  ds_read_b128 v[56:59], v254 offset:22528
  buffer_load_dword v247, v245, s[28:31], 0 offen sc1
  v_exp_f32 v96, v96
  v_exp_f32 v97, v97
  v_exp_f32 v98, v98
  v_exp_f32 v99, v99
  s_waitcnt lgkmcnt(6)
  v_mfma_f32_32x32x16_bf16 v[112:127], v[8:11], v[128:131], 0
  ds_read_b128 v[60:63], v254 offset:23040
  v_exp_f32 v100, v100
  v_exp_f32 v101, v101
  v_exp_f32 v102, v102
  v_exp_f32 v103, v103
  s_waitcnt lgkmcnt(6)
  v_mfma_f32_32x32x16_bf16 v[112:127], v[12:15], v[132:135], v[112:127]
  ds_read_b128 v[8:11], v254 offset:21504
  v_cvt_pk_bf16_f32 v176, v96, v97
  v_cvt_pk_bf16_f32 v177, v98, v99
  v_cvt_pk_bf16_f32 v178, v100, v101
  v_cvt_pk_bf16_f32 v179, v102, v103
  s_waitcnt lgkmcnt(6)
  v_mfma_f32_32x32x16_bf16 v[112:127], v[16:19], v[136:139], v[112:127]
  ds_read_b128 v[12:15], v254 offset:22016
  v_exp_f32 v104, v104
  v_exp_f32 v105, v105
  v_exp_f32 v106, v106
  v_exp_f32 v107, v107
  s_waitcnt lgkmcnt(6)
  v_mfma_f32_32x32x16_bf16 v[112:127], v[20:23], v[140:143], v[112:127]
  ds_read_b128 v[16:19], v254 offset:20480
  v_exp_f32 v108, v108
  v_exp_f32 v109, v109
  v_exp_f32 v110, v110
  v_exp_f32 v111, v111
  s_waitcnt lgkmcnt(6)
  v_mfma_f32_32x32x16_bf16 v[112:127], v[48:51], v[144:147], v[112:127]
  ds_read_b128 v[20:23], v254 offset:20992
  v_cvt_pk_bf16_f32 v180, v104, v105
  v_cvt_pk_bf16_f32 v181, v106, v107
  v_cvt_pk_bf16_f32 v182, v108, v109
  v_cvt_pk_bf16_f32 v183, v110, v111
  s_cmp_eq_u32 s18, 6
  s_cbranch_scc1 P2_ob7
P2_zb7:
  v_mfma_f32_32x32x16_bf16 v[80:95], v[36:39], v[44:47], v[216:231]
  buffer_load_dwordx2 v[240:241], v252, s[28:31], 0 offen sc1
  v_exp_f32 v64, v64
  v_exp_f32 v65, v65
  v_exp_f32 v66, v66
  v_exp_f32 v67, v67
  s_waitcnt lgkmcnt(6)
  v_mfma_f32_32x32x16_bf16 v[112:127], v[52:55], v[148:151], v[112:127]
  ds_read_b128 v[48:51], v254 offset:19456
  v_exp_f32 v68, v68
  v_exp_f32 v69, v69
  v_exp_f32 v70, v70
  v_exp_f32 v71, v71
  s_waitcnt lgkmcnt(6)
  v_mfma_f32_32x32x16_bf16 v[112:127], v[56:59], v[152:155], v[112:127]
  ds_read_b128 v[52:55], v254 offset:19968
  v_cvt_pk_bf16_f32 v24, v64, v65
  v_cvt_pk_bf16_f32 v25, v66, v67
  v_cvt_pk_bf16_f32 v26, v68, v69
  v_cvt_pk_bf16_f32 v27, v70, v71
  s_waitcnt lgkmcnt(6)
  v_mfma_f32_32x32x16_bf16 v[112:127], v[60:63], v[156:159], v[112:127]
  ds_read_b128 v[56:59], v254 offset:18432
  v_exp_f32 v72, v72
  v_exp_f32 v73, v73
  v_exp_f32 v74, v74
  v_exp_f32 v75, v75
  s_waitcnt lgkmcnt(6)
  v_mfma_f32_32x32x16_bf16 v[112:127], v[8:11], v[160:163], v[112:127]
  ds_read_b128 v[60:63], v254 offset:18944
  v_exp_f32 v76, v76
  v_exp_f32 v77, v77
  v_exp_f32 v78, v78
  v_exp_f32 v79, v79
  s_waitcnt lgkmcnt(6)
  v_mfma_f32_32x32x16_bf16 v[112:127], v[12:15], v[164:167], v[112:127]
  ds_read_b128 v[8:11], v254 offset:17408
  v_cvt_pk_bf16_f32 v28, v72, v73
  v_cvt_pk_bf16_f32 v29, v74, v75
  v_cvt_pk_bf16_f32 v30, v76, v77
  v_cvt_pk_bf16_f32 v31, v78, v79
  v_exp_f32 v80, v80
  v_exp_f32 v81, v81
  v_exp_f32 v82, v82
  v_exp_f32 v83, v83
  s_waitcnt lgkmcnt(6)
  v_mfma_f32_32x32x16_bf16 v[112:127], v[16:19], v[168:171], v[112:127]
  ds_read_b128 v[12:15], v254 offset:17920
  v_exp_f32 v84, v84
  v_exp_f32 v85, v85
  v_exp_f32 v86, v86
  v_exp_f32 v87, v87
  s_waitcnt lgkmcnt(6)
  v_mfma_f32_32x32x16_bf16 v[112:127], v[20:23], v[172:175], v[112:127]
  v_cvt_pk_bf16_f32 v32, v80, v81
  v_cvt_pk_bf16_f32 v33, v82, v83
  v_cvt_pk_bf16_f32 v34, v84, v85
  v_cvt_pk_bf16_f32 v35, v86, v87
  s_waitcnt lgkmcnt(5)
  v_mfma_f32_32x32x16_bf16 v[112:127], v[48:51], v[176:179], v[112:127]
  v_exp_f32 v88, v88
  v_exp_f32 v89, v89
  v_exp_f32 v90, v90
  v_exp_f32 v91, v91
  s_waitcnt lgkmcnt(4)
  v_mfma_f32_32x32x16_bf16 v[112:127], v[52:55], v[180:183], v[112:127]
  v_exp_f32 v92, v92
  v_exp_f32 v93, v93
  v_exp_f32 v94, v94
  v_exp_f32 v95, v95
  s_waitcnt lgkmcnt(3)
  v_mfma_f32_32x32x16_bf16 v[112:127], v[56:59], v[24:27], v[112:127]
  v_cvt_pk_bf16_f32 v36, v88, v89
  v_cvt_pk_bf16_f32 v37, v90, v91
  v_cvt_pk_bf16_f32 v38, v92, v93
  v_cvt_pk_bf16_f32 v39, v94, v95
  s_waitcnt vmcnt(0)
  v_and_b32 v240, v240, v241
  v_cmp_eq_u32 vcc, 0, v240
  s_cbranch_vccnz P2_nh
  s_lshl_b32 s57, s54, 12
  s_add_u32 m0, s57, 0x10000
  s_mov_b32 s56, 0
  buffer_load_dwordx4 v250, s[28:31], s56 offen offset:0 sc1 lds
  s_add_u32 s56, s56, 7168
  buffer_load_dwordx4 v250, s[28:31], s56 offen offset:1024 sc1 lds
  s_add_u32 s56, s56, 7168
  buffer_load_dwordx4 v250, s[28:31], s56 offen offset:2048 sc1 lds
  s_add_u32 s56, s56, 7168
  buffer_load_dwordx4 v250, s[28:31], s56 offen offset:3072 sc1 lds
  s_mov_b32 s53, 1
P2_nh:
  s_waitcnt lgkmcnt(2)
  v_mfma_f32_32x32x16_bf16 v[112:127], v[60:63], v[28:31], v[112:127]
  s_waitcnt lgkmcnt(1)
  v_mfma_f32_32x32x16_bf16 v[112:127], v[8:11], v[32:35], v[112:127]
  s_waitcnt lgkmcnt(0)
  v_mfma_f32_32x32x16_bf16 v[112:127], v[12:15], v[36:39], v[112:127]
  s_cmp_lg_u32 s53, 0
  s_cbranch_scc1 P2_l1
  buffer_load_dwordx2 v[240:241], v252, s[28:31], 0 offen sc1
P2_l1:
  s_mov_b32 s40, s60
  s_mov_b32 s41, s61
  s_mov_b32 s42, 0x200000
  s_mov_b32 s43, 0x20000
  s_lshr_b32 s16, s2, 5
  s_mul_i32 s16, s16, 2048
  s_xor_b32 s24, s16, 0
  s_xor_b32 s25, s16, 2048
  s_xor_b32 s34, s16, 4096
  s_xor_b32 s35, s16, 6144
  s_xor_b32 s44, s16, 8192
  s_xor_b32 s45, s16, 10240
  s_xor_b32 s46, s16, 12288
  s_xor_b32 s47, s16, 14336
  v_add_f32 v1, |v112|, |v113|
  v_add_f32 v2, |v114|, |v115|
  v_add_f32 v1, v1, |v116|
  v_add_f32 v2, v2, |v117|
  v_add_f32 v1, v1, |v118|
  v_add_f32 v2, v2, |v119|
  s_mov_b32 s33, 0x35800000
  v_add_f32 v1, v1, v2
  v_fma_f32 v1, v1, s33, v120
  v_cmp_ngt_f32 vcc, 0x7b800000, v1
  s_cbranch_vccnz P2_fb
P2_fbret:
  v_rcp_f32 v2, v120
  s_nop 0
  v_pk_mul_f32 v[112:113], v[112:113], v[2:3] op_sel:[0,0] op_sel_hi:[1,0]
  v_pk_mul_f32 v[114:115], v[114:115], v[2:3] op_sel:[0,0] op_sel_hi:[1,0]
  v_pk_mul_f32 v[116:117], v[116:117], v[2:3] op_sel:[0,0] op_sel_hi:[1,0]
  v_pk_mul_f32 v[118:119], v[118:119], v[2:3] op_sel:[0,0] op_sel_hi:[1,0]
  v_cvt_pk_bf16_f32 v140, v112, v113
  v_cvt_pk_bf16_f32 v141, v114, v115
  v_cvt_pk_bf16_f32 v142, v116, v117
  v_cvt_pk_bf16_f32 v143, v118, v119
  v_min_u32 v140, -2, v140
  v_min_u32 v141, -2, v141
  v_min_u32 v142, -2, v142
  v_min_u32 v143, -2, v143
  ds_write_b128 v212, v[140:143] offset:0xc000
  s_waitcnt lgkmcnt(0)
  s_barrier
  ds_read_b128 v[140:143], v253 offset:0xc000
  s_waitcnt lgkmcnt(0)
  buffer_store_dwordx4 v[140:143], v213, s[28:31], 0 offen sc1
  s_waitcnt vmcnt(1)
  s_cmp_lg_u32 s53, 0
  s_cbranch_scc1 P2_l2
  s_mov_b32 s48, 0
  s_branch Lpoll16c
Lpoll16:
  s_sleep 8
Lpoll16l:
  buffer_load_dwordx2 v[240:241], v252, s[28:31], 0 offen sc1
  s_waitcnt vmcnt(0)
Lpoll16c:
  v_and_b32 v240, v240, v241
  v_cmp_gt_u32 vcc, 1, v240
  s_add_u32 s48, s48, 1
  s_cmp_ge_u32 s48, 65536
  s_cbranch_scc1 Lpoll16x
  s_and_b64 exec, exec, vcc
  s_cbranch_scc1 Lpoll16
Lpoll16x:
  s_mov_b64 exec, -1
  s_lshl_b32 s57, s54, 12
  s_add_u32 m0, s57, 0x10000
  s_mov_b32 s56, 0
  buffer_load_dwordx4 v250, s[28:31], s56 offen offset:0 sc1 lds
  s_add_u32 s56, s56, 7168
  buffer_load_dwordx4 v250, s[28:31], s56 offen offset:1024 sc1 lds
  s_add_u32 s56, s56, 7168
  buffer_load_dwordx4 v250, s[28:31], s56 offen offset:2048 sc1 lds
  s_add_u32 s56, s56, 7168
  buffer_load_dwordx4 v250, s[28:31], s56 offen offset:3072 sc1 lds
  s_mov_b32 s53, 1
  s_waitcnt vmcnt(0)
P2_l2:
  v_pk_mul_f32 v[188:189], v[188:189], v[246:247] op_sel:[0,1] op_sel_hi:[1,1]
  v_pk_mul_f32 v[190:191], v[190:191], v[246:247] op_sel:[0,1] op_sel_hi:[1,1]
  v_pk_mul_f32 v[192:193], v[192:193], v[246:247] op_sel:[0,1] op_sel_hi:[1,1]
  v_pk_mul_f32 v[194:195], v[194:195], v[246:247] op_sel:[0,1] op_sel_hi:[1,1]
  v_pk_mul_f32 v[196:197], v[196:197], v[246:247] op_sel:[0,1] op_sel_hi:[1,1]
  v_pk_mul_f32 v[198:199], v[198:199], v[246:247] op_sel:[0,1] op_sel_hi:[1,1]
  v_pk_mul_f32 v[200:201], v[200:201], v[246:247] op_sel:[0,1] op_sel_hi:[1,1]
  v_pk_mul_f32 v[202:203], v[202:203], v[246:247] op_sel:[0,1] op_sel_hi:[1,1]
  v_cvt_pk_bf16_f32 v144, v188, v189
  v_cvt_pk_bf16_f32 v145, v190, v191
  v_xor_b32 v153, v215, v144
  v_xor_b32 v152, v214, v145
  v_cvt_pk_bf16_f32 v146, v192, v193
  v_cvt_pk_bf16_f32 v147, v194, v195
  v_xor_b32 v155, v215, v146
  v_xor_b32 v154, v214, v147
  v_cvt_pk_bf16_f32 v148, v196, v197
  v_cvt_pk_bf16_f32 v149, v198, v199
  v_xor_b32 v157, v215, v148
  v_xor_b32 v156, v214, v149
  v_cvt_pk_bf16_f32 v150, v200, v201
  v_cvt_pk_bf16_f32 v151, v202, v203
  v_xor_b32 v159, v215, v150
  v_xor_b32 v158, v214, v151
  v_add_f32 v247, 1.0, v247
  v_rcp_f32 v247, v247
  s_and_b32 s36, s2, 15
  s_cbranch_scc1 P3_wdone
  s_bitcmp0_b32 s2, 4
  s_cselect_b64 vcc, -1, 0
  v_cndmask_b32 v145, v144, 0, vcc
  v_cndmask_b32 v144, 0, v144, vcc
  v_cndmask_b32 v147, v146, 0, vcc
  v_cndmask_b32 v146, 0, v146, vcc
  v_cndmask_b32 v149, v148, 0, vcc
  v_cndmask_b32 v148, 0, v148, vcc
  v_cndmask_b32 v151, v150, 0, vcc
  v_cndmask_b32 v150, 0, v150, vcc
  v_cndmask_b32 v153, v152, 0, vcc
  v_cndmask_b32 v152, 0, v152, vcc
  v_cndmask_b32 v155, v154, 0, vcc
  v_cndmask_b32 v154, 0, v154, vcc
  v_cndmask_b32 v157, v156, 0, vcc
  v_cndmask_b32 v156, 0, v156, vcc
  v_cndmask_b32 v159, v158, 0, vcc
  v_cndmask_b32 v158, 0, v158, vcc
P3_wdone:
  s_barrier
  v_xor_b32 v6, 0x2000, v204
  ds_read_b128 v[8:11], v204 offset:0
  ds_read_b128 v[12:15], v6 offset:0
  ds_read_b128 v[16:19], v204 offset:1024
  ds_read_b128 v[20:23], v6 offset:1024
  ds_read_b128 v[24:27], v204 offset:16384
  ds_read_b128 v[28:31], v6 offset:16384
  ds_read_b128 v[32:35], v204 offset:17408
  ds_read_b128 v[36:39], v6 offset:17408
  s_mov_b32 s36, 0
  s_mov_b32 s48, 0
  s_waitcnt lgkmcnt(0)
  v_mfma_f32_32x32x16_bf16 v[160:175], v[8:11], v[144:147], 0
  v_xor_b32 v6, 0, v205
  ds_read_b64_tr_b16 v[40:41], v6 offset:0
  ds_read_b64_tr_b16 v[42:43], v6 offset:512
  v_xor_b32 v6, 64, v205
  ds_read_b64_tr_b16 v[44:45], v6 offset:0
  ds_read_b64_tr_b16 v[46:47], v6 offset:512
  v_mfma_f32_32x32x16_bf16 v[176:191], v[12:15], v[144:147], 0
  v_xor_b32 v6, 2048, v205
  ds_read_b64_tr_b16 v[48:49], v6 offset:0
  ds_read_b64_tr_b16 v[50:51], v6 offset:512
  v_xor_b32 v6, 2112, v205
  ds_read_b64_tr_b16 v[52:53], v6 offset:0
  ds_read_b64_tr_b16 v[54:55], v6 offset:512
  v_mfma_f32_32x32x16_bf16 v[160:175], v[16:19], v[148:151], v[160:175]
  v_xor_b32 v6, 4096, v205
  ds_read_b64_tr_b16 v[56:57], v6 offset:0
  ds_read_b64_tr_b16 v[58:59], v6 offset:512
  v_xor_b32 v6, 4160, v205
  ds_read_b64_tr_b16 v[60:61], v6 offset:0
  ds_read_b64_tr_b16 v[62:63], v6 offset:512
  s_waitcnt lgkmcnt(3)
  v_mfma_f32_32x32x16_bf16 v[176:191], v[20:23], v[148:151], v[176:191]
  v_xor_b32 v6, 6144, v205
  ds_read_b64_tr_b16 v[64:65], v6 offset:0
  ds_read_b64_tr_b16 v[66:67], v6 offset:512
  v_xor_b32 v6, 6208, v205
  ds_read_b64_tr_b16 v[68:69], v6 offset:0
  ds_read_b64_tr_b16 v[70:71], v6 offset:512
  v_mfma_f32_32x32x16_bf16 v[160:175], v[24:27], v[152:155], v[160:175]
  v_xor_b32 v6, 8192, v205
  ds_read_b64_tr_b16 v[72:73], v6 offset:0
  ds_read_b64_tr_b16 v[74:75], v6 offset:512
  v_xor_b32 v6, 8256, v205
  ds_read_b64_tr_b16 v[76:77], v6 offset:0
  ds_read_b64_tr_b16 v[78:79], v6 offset:512
  v_mfma_f32_32x32x16_bf16 v[176:191], v[28:31], v[152:155], v[176:191]
  v_xor_b32 v6, 10240, v205
  ds_read_b64_tr_b16 v[80:81], v6 offset:0
  ds_read_b64_tr_b16 v[82:83], v6 offset:512
  v_xor_b32 v6, 10304, v205
  ds_read_b64_tr_b16 v[84:85], v6 offset:0
  ds_read_b64_tr_b16 v[86:87], v6 offset:512
  s_waitcnt lgkmcnt(3)
  v_mfma_f32_32x32x16_bf16 v[160:175], v[32:35], v[156:159], v[160:175]
  v_xor_b32 v6, 12288, v205
  ds_read_b64_tr_b16 v[88:89], v6 offset:0
  ds_read_b64_tr_b16 v[90:91], v6 offset:512
  v_xor_b32 v6, 12352, v205
  ds_read_b64_tr_b16 v[92:93], v6 offset:0
  ds_read_b64_tr_b16 v[94:95], v6 offset:512
  v_mfma_f32_32x32x16_bf16 v[176:191], v[36:39], v[156:159], v[176:191]
  v_xor_b32 v6, 14336, v205
  ds_read_b64_tr_b16 v[96:97], v6 offset:0
  ds_read_b64_tr_b16 v[98:99], v6 offset:512
  v_xor_b32 v6, 14400, v205
  ds_read_b64_tr_b16 v[100:101], v6 offset:0
  ds_read_b64_tr_b16 v[102:103], v6 offset:512
  buffer_load_dwordx4 v[104:107], v211, s[28:31], s24 offen sc1
  buffer_load_dwordx4 v[108:111], v211, s[28:31], s25 offen sc1
  buffer_load_dwordx4 v[112:115], v211, s[28:31], s34 offen sc1
  buffer_load_dwordx4 v[116:119], v211, s[28:31], s35 offen sc1
  buffer_load_dwordx4 v[120:123], v211, s[28:31], s44 offen sc1
  buffer_load_dwordx4 v[124:127], v211, s[28:31], s45 offen sc1
  buffer_load_dwordx4 v[128:131], v211, s[28:31], s46 offen sc1
  buffer_load_dwordx4 v[132:135], v211, s[28:31], s47 offen sc1
  s_mov_b32 s36, 0
  s_waitcnt lgkmcnt(0)
  s_waitcnt vmcnt(7)
  v_max3_u32 v6, v104, v105, v106
  v_max_u32 v6, v6, v107
  v_cmp_eq_u32 vcc, -1, v6
  s_nop 0
  s_mov_b64 s[4:5], vcc
  s_cbranch_vccnz P3_f0
  v_mfma_f32_32x32x16_bf16 v[160:175], v[40:43], v[104:107], v[160:175]
  v_mfma_f32_32x32x16_bf16 v[176:191], v[44:47], v[104:107], v[176:191]
  s_bitset1_b32 s36, 0
P3_f0:
  s_waitcnt vmcnt(6)
  v_max3_u32 v6, v108, v109, v110
  v_max_u32 v6, v6, v111
  v_cmp_eq_u32 vcc, -1, v6
  s_nop 0
  s_mov_b64 s[6:7], vcc
  s_cbranch_vccnz P3_f1
  v_mfma_f32_32x32x16_bf16 v[160:175], v[48:51], v[108:111], v[160:175]
  v_mfma_f32_32x32x16_bf16 v[176:191], v[52:55], v[108:111], v[176:191]
  s_bitset1_b32 s36, 1
P3_f1:
  s_waitcnt vmcnt(5)
  v_max3_u32 v6, v112, v113, v114
  v_max_u32 v6, v6, v115
  v_cmp_eq_u32 vcc, -1, v6
  s_nop 0
  s_mov_b64 s[8:9], vcc
  s_cbranch_vccnz P3_f2
  v_mfma_f32_32x32x16_bf16 v[160:175], v[56:59], v[112:115], v[160:175]
  v_mfma_f32_32x32x16_bf16 v[176:191], v[60:63], v[112:115], v[176:191]
  s_bitset1_b32 s36, 2
P3_f2:
  s_waitcnt vmcnt(4)
  v_max3_u32 v6, v116, v117, v118
  v_max_u32 v6, v6, v119
  v_cmp_eq_u32 vcc, -1, v6
  s_nop 0
  s_mov_b64 s[10:11], vcc
  s_cbranch_vccnz P3_f3
  v_mfma_f32_32x32x16_bf16 v[160:175], v[64:67], v[116:119], v[160:175]
  v_mfma_f32_32x32x16_bf16 v[176:191], v[68:71], v[116:119], v[176:191]
  s_bitset1_b32 s36, 3
P3_f3:
  s_waitcnt vmcnt(3)
  v_max3_u32 v6, v120, v121, v122
  v_max_u32 v6, v6, v123
  v_cmp_eq_u32 vcc, -1, v6
  s_nop 0
  s_mov_b64 s[12:13], vcc
  s_cbranch_vccnz P3_f4
  v_mfma_f32_32x32x16_bf16 v[160:175], v[72:75], v[120:123], v[160:175]
  v_mfma_f32_32x32x16_bf16 v[176:191], v[76:79], v[120:123], v[176:191]
  s_bitset1_b32 s36, 4
P3_f4:
  s_waitcnt vmcnt(2)
  v_max3_u32 v6, v124, v125, v126
  v_max_u32 v6, v6, v127
  v_cmp_eq_u32 vcc, -1, v6
  s_nop 0
  s_mov_b64 s[32:33], vcc
  s_cbranch_vccnz P3_f5
  v_mfma_f32_32x32x16_bf16 v[160:175], v[80:83], v[124:127], v[160:175]
  v_mfma_f32_32x32x16_bf16 v[176:191], v[84:87], v[124:127], v[176:191]
  s_bitset1_b32 s36, 5
P3_f5:
  s_waitcnt vmcnt(1)
  v_max3_u32 v6, v128, v129, v130
  v_max_u32 v6, v6, v131
  v_cmp_eq_u32 vcc, -1, v6
  s_nop 0
  s_mov_b64 s[26:27], vcc
  s_cbranch_vccnz P3_f6
  v_mfma_f32_32x32x16_bf16 v[160:175], v[88:91], v[128:131], v[160:175]
  v_mfma_f32_32x32x16_bf16 v[176:191], v[92:95], v[128:131], v[176:191]
  s_bitset1_b32 s36, 6
P3_f6:
  s_waitcnt vmcnt(0)
  v_max3_u32 v6, v132, v133, v134
  v_max_u32 v6, v6, v135
  v_cmp_eq_u32 vcc, -1, v6
  s_nop 0
  s_mov_b64 s[38:39], vcc
  s_cbranch_vccnz P3_f7
  v_mfma_f32_32x32x16_bf16 v[160:175], v[96:99], v[132:135], v[160:175]
  v_mfma_f32_32x32x16_bf16 v[176:191], v[100:103], v[132:135], v[176:191]
  s_bitset1_b32 s36, 7
P3_f7:
  s_mov_b32 s37, -1
  s_branch P3_chk
P3_sweep:
  s_waitcnt vmcnt(0)
  s_mov_b32 s37, s36
  s_bitcmp1_b32 s36, 0
  s_cbranch_scc1 P3_s0
  v_max3_u32 v6, v104, v105, v106
  v_max_u32 v6, v6, v107
  v_cmp_eq_u32 vcc, -1, v6
  s_nop 0
  s_mov_b64 s[4:5], vcc
  s_cbranch_vccnz P3_s0
  v_mfma_f32_32x32x16_bf16 v[160:175], v[40:43], v[104:107], v[160:175]
  v_mfma_f32_32x32x16_bf16 v[176:191], v[44:47], v[104:107], v[176:191]
  s_bitset1_b32 s36, 0
P3_s0:
  s_bitcmp1_b32 s36, 1
  s_cbranch_scc1 P3_s1
  v_max3_u32 v6, v108, v109, v110
  v_max_u32 v6, v6, v111
  v_cmp_eq_u32 vcc, -1, v6
  s_nop 0
  s_mov_b64 s[6:7], vcc
  s_cbranch_vccnz P3_s1
  v_mfma_f32_32x32x16_bf16 v[160:175], v[48:51], v[108:111], v[160:175]
  v_mfma_f32_32x32x16_bf16 v[176:191], v[52:55], v[108:111], v[176:191]
  s_bitset1_b32 s36, 1
P3_s1:
  s_bitcmp1_b32 s36, 2
  s_cbranch_scc1 P3_s2
  v_max3_u32 v6, v112, v113, v114
  v_max_u32 v6, v6, v115
  v_cmp_eq_u32 vcc, -1, v6
  s_nop 0
  s_mov_b64 s[8:9], vcc
  s_cbranch_vccnz P3_s2
  v_mfma_f32_32x32x16_bf16 v[160:175], v[56:59], v[112:115], v[160:175]
  v_mfma_f32_32x32x16_bf16 v[176:191], v[60:63], v[112:115], v[176:191]
  s_bitset1_b32 s36, 2
P3_s2:
  s_bitcmp1_b32 s36, 3
  s_cbranch_scc1 P3_s3
  v_max3_u32 v6, v116, v117, v118
  v_max_u32 v6, v6, v119
  v_cmp_eq_u32 vcc, -1, v6
  s_nop 0
  s_mov_b64 s[10:11], vcc
  s_cbranch_vccnz P3_s3
  v_mfma_f32_32x32x16_bf16 v[160:175], v[64:67], v[116:119], v[160:175]
  v_mfma_f32_32x32x16_bf16 v[176:191], v[68:71], v[116:119], v[176:191]
  s_bitset1_b32 s36, 3
P3_s3:
  s_bitcmp1_b32 s36, 4
  s_cbranch_scc1 P3_s4
  v_max3_u32 v6, v120, v121, v122
  v_max_u32 v6, v6, v123
  v_cmp_eq_u32 vcc, -1, v6
  s_nop 0
  s_mov_b64 s[12:13], vcc
  s_cbranch_vccnz P3_s4
  v_mfma_f32_32x32x16_bf16 v[160:175], v[72:75], v[120:123], v[160:175]
  v_mfma_f32_32x32x16_bf16 v[176:191], v[76:79], v[120:123], v[176:191]
  s_bitset1_b32 s36, 4
P3_s4:
  s_bitcmp1_b32 s36, 5
  s_cbranch_scc1 P3_s5
  v_max3_u32 v6, v124, v125, v126
  v_max_u32 v6, v6, v127
  v_cmp_eq_u32 vcc, -1, v6
  s_nop 0
  s_mov_b64 s[32:33], vcc
  s_cbranch_vccnz P3_s5
  v_mfma_f32_32x32x16_bf16 v[160:175], v[80:83], v[124:127], v[160:175]
  v_mfma_f32_32x32x16_bf16 v[176:191], v[84:87], v[124:127], v[176:191]
  s_bitset1_b32 s36, 5
P3_s5:
  s_bitcmp1_b32 s36, 6
  s_cbranch_scc1 P3_s6
  v_max3_u32 v6, v128, v129, v130
  v_max_u32 v6, v6, v131
  v_cmp_eq_u32 vcc, -1, v6
  s_nop 0
  s_mov_b64 s[26:27], vcc
  s_cbranch_vccnz P3_s6
  v_mfma_f32_32x32x16_bf16 v[160:175], v[88:91], v[128:131], v[160:175]
  v_mfma_f32_32x32x16_bf16 v[176:191], v[92:95], v[128:131], v[176:191]
  s_bitset1_b32 s36, 6
P3_s6:
  s_bitcmp1_b32 s36, 7
  s_cbranch_scc1 P3_s7
  v_max3_u32 v6, v132, v133, v134
  v_max_u32 v6, v6, v135
  v_cmp_eq_u32 vcc, -1, v6
  s_nop 0
  s_mov_b64 s[38:39], vcc
  s_cbranch_vccnz P3_s7
  v_mfma_f32_32x32x16_bf16 v[160:175], v[96:99], v[132:135], v[160:175]
  v_mfma_f32_32x32x16_bf16 v[176:191], v[100:103], v[132:135], v[176:191]
  s_bitset1_b32 s36, 7
P3_s7:
P3_chk:
  s_cmp_eq_u32 s36, 0xff
  s_cbranch_scc1 P3_red
  s_add_u32 s48, s48, 1
  s_cmp_ge_u32 s48, 65536
  s_cbranch_scc1 P3_red
  s_ff0_i32_b32 s49, s36
  s_lshl_b32 s49, 1, s49
  s_not_b32 s49, s49
  s_cmp_lg_u32 s37, s36
  s_cselect_b32 s37, s36, s49
  s_sleep 2
  s_bitcmp1_b32 s37, 0
  s_cbranch_scc1 P3_r0
  s_mov_b64 exec, s[4:5]
  buffer_load_dwordx4 v[104:107], v211, s[28:31], s24 offen sc1
P3_r0:
  s_bitcmp1_b32 s37, 1
  s_cbranch_scc1 P3_r1
  s_mov_b64 exec, s[6:7]
  buffer_load_dwordx4 v[108:111], v211, s[28:31], s25 offen sc1
P3_r1:
  s_bitcmp1_b32 s37, 2
  s_cbranch_scc1 P3_r2
  s_mov_b64 exec, s[8:9]
  buffer_load_dwordx4 v[112:115], v211, s[28:31], s34 offen sc1
P3_r2:
  s_bitcmp1_b32 s37, 3
  s_cbranch_scc1 P3_r3
  s_mov_b64 exec, s[10:11]
  buffer_load_dwordx4 v[116:119], v211, s[28:31], s35 offen sc1
P3_r3:
  s_bitcmp1_b32 s37, 4
  s_cbranch_scc1 P3_r4
  s_mov_b64 exec, s[12:13]
  buffer_load_dwordx4 v[120:123], v211, s[28:31], s44 offen sc1
P3_r4:
  s_bitcmp1_b32 s37, 5
  s_cbranch_scc1 P3_r5
  s_mov_b64 exec, s[32:33]
  buffer_load_dwordx4 v[124:127], v211, s[28:31], s45 offen sc1
P3_r5:
  s_bitcmp1_b32 s37, 6
  s_cbranch_scc1 P3_r6
  s_mov_b64 exec, s[26:27]
  buffer_load_dwordx4 v[128:131], v211, s[28:31], s46 offen sc1
P3_r6:
  s_bitcmp1_b32 s37, 7
  s_cbranch_scc1 P3_r7
  s_mov_b64 exec, s[38:39]
  buffer_load_dwordx4 v[132:135], v211, s[28:31], s47 offen sc1
P3_r7:
  s_mov_b64 exec, -1
  s_branch P3_sweep
P3_red:
  s_nop 7
  ds_write_b128 v208, v[168:171] offset:0
  ds_write_b128 v208, v[172:175] offset:1024
  ds_write_b128 v209, v[176:179] offset:16384
  ds_write_b128 v209, v[180:183] offset:17408
  ds_write_b128 v210, v[184:187] offset:32768
  ds_write_b128 v210, v[188:191] offset:33792
  s_waitcnt lgkmcnt(0)
  s_barrier
  ds_read_b128 v[40:43], v207 offset:0
  ds_read_b128 v[44:47], v207 offset:1024
  ds_read_b128 v[48:51], v207 offset:16384
  ds_read_b128 v[52:55], v207 offset:17408
  ds_read_b128 v[56:59], v207 offset:32768
  ds_read_b128 v[60:63], v207 offset:33792
  s_waitcnt lgkmcnt(4)
  v_pk_add_f32 v[160:161], v[160:161], v[40:41]
  v_pk_add_f32 v[162:163], v[162:163], v[42:43]
  v_pk_add_f32 v[164:165], v[164:165], v[44:45]
  v_pk_add_f32 v[166:167], v[166:167], v[46:47]
  s_waitcnt lgkmcnt(2)
  v_pk_add_f32 v[160:161], v[160:161], v[48:49]
  v_pk_add_f32 v[162:163], v[162:163], v[50:51]
  v_pk_add_f32 v[164:165], v[164:165], v[52:53]
  v_pk_add_f32 v[166:167], v[166:167], v[54:55]
  s_waitcnt lgkmcnt(0)
  v_pk_add_f32 v[160:161], v[160:161], v[56:57]
  v_pk_add_f32 v[162:163], v[162:163], v[58:59]
  v_pk_add_f32 v[164:165], v[164:165], v[60:61]
  v_pk_add_f32 v[166:167], v[166:167], v[62:63]
  v_pk_mul_f32 v[160:161], v[160:161], v[246:247] op_sel:[0,1] op_sel_hi:[1,1]
  v_pk_mul_f32 v[162:163], v[162:163], v[246:247] op_sel:[0,1] op_sel_hi:[1,1]
  v_pk_mul_f32 v[164:165], v[164:165], v[246:247] op_sel:[0,1] op_sel_hi:[1,1]
  v_pk_mul_f32 v[166:167], v[166:167], v[246:247] op_sel:[0,1] op_sel_hi:[1,1]
  v_cvt_pk_bf16_f32 v40, v160, v161
  v_cvt_pk_bf16_f32 v41, v162, v163
  v_cvt_pk_bf16_f32 v42, v164, v165
  v_cvt_pk_bf16_f32 v43, v166, v167
  buffer_store_dwordx4 v[40:43], v206, s[40:43], 0 offen
F_done:
  s_endpgm
P2_ob1:
  s_nop 6
  v_mov_b32 v216, v249
  v_mov_b32 v217, v249
  v_mov_b32 v218, v249
  v_mov_b32 v219, v249
  v_mov_b32 v220, v249
  v_mov_b32 v221, v249
  v_mov_b32 v222, v249
  v_mov_b32 v223, v249
  v_mov_b32 v224, v249
  v_mov_b32 v225, v249
  v_mov_b32 v226, v249
  v_mov_b32 v227, v249
  v_mov_b32 v228, v249
  v_mov_b32 v229, v249
  v_mov_b32 v230, v249
  v_mov_b32 v231, v249
  s_nop 0
  s_branch P2_zb1
P2_ob2:
  s_nop 6
  v_mov_b32 v216, v249
  v_mov_b32 v217, v249
  v_mov_b32 v218, v249
  v_mov_b32 v219, v249
  v_mov_b32 v220, v249
  v_mov_b32 v221, v249
  v_mov_b32 v222, v249
  v_mov_b32 v223, v249
  v_mov_b32 v224, v249
  v_mov_b32 v225, v249
  v_mov_b32 v226, v249
  v_mov_b32 v227, v249
  v_mov_b32 v228, v249
  v_mov_b32 v229, v249
  v_mov_b32 v230, v249
  v_mov_b32 v231, v249
  s_nop 0
  s_branch P2_zb2
P2_ob3:
  s_nop 6
  v_mov_b32 v216, v249
  v_mov_b32 v217, v249
  v_mov_b32 v218, v249
  v_mov_b32 v219, v249
  v_mov_b32 v220, v249
  v_mov_b32 v221, v249
  v_mov_b32 v222, v249
  v_mov_b32 v223, v249
  v_mov_b32 v224, v249
  v_mov_b32 v225, v249
  v_mov_b32 v226, v249
  v_mov_b32 v227, v249
  v_mov_b32 v228, v249
  v_mov_b32 v229, v249
  v_mov_b32 v230, v249
  v_mov_b32 v231, v249
  s_nop 0
  s_branch P2_zb3
P2_ob4:
  s_nop 6
  v_mov_b32 v216, v249
  v_mov_b32 v217, v249
  v_mov_b32 v218, v249
  v_mov_b32 v219, v249
  v_mov_b32 v220, v249
  v_mov_b32 v221, v249
  v_mov_b32 v222, v249
  v_mov_b32 v223, v249
  v_mov_b32 v224, v249
  v_mov_b32 v225, v249
  v_mov_b32 v226, v249
  v_mov_b32 v227, v249
  v_mov_b32 v228, v249
  v_mov_b32 v229, v249
  v_mov_b32 v230, v249
  v_mov_b32 v231, v249
  s_nop 0
  s_branch P2_zb4
P2_ob5:
  s_nop 6
  v_mov_b32 v216, v249
  v_mov_b32 v217, v249
  v_mov_b32 v218, v249
  v_mov_b32 v219, v249
  v_mov_b32 v220, v249
  v_mov_b32 v221, v249
  v_mov_b32 v222, v249
  v_mov_b32 v223, v249
  v_mov_b32 v224, v249
  v_mov_b32 v225, v249
  v_mov_b32 v226, v249
  v_mov_b32 v227, v249
  v_mov_b32 v228, v249
  v_mov_b32 v229, v249
  v_mov_b32 v230, v249
  v_mov_b32 v231, v249
  s_nop 0
  s_branch P2_zb5
P2_ob6:
  s_nop 6
  v_mov_b32 v216, v249
  v_mov_b32 v217, v249
  v_mov_b32 v218, v249
  v_mov_b32 v219, v249
  v_mov_b32 v220, v249
  v_mov_b32 v221, v249
  v_mov_b32 v222, v249
  v_mov_b32 v223, v249
  v_mov_b32 v224, v249
  v_mov_b32 v225, v249
  v_mov_b32 v226, v249
  v_mov_b32 v227, v249
  v_mov_b32 v228, v249
  v_mov_b32 v229, v249
  v_mov_b32 v230, v249
  v_mov_b32 v231, v249
  s_nop 0
  s_branch P2_zb6
P2_ob7:
  s_nop 6
  v_mov_b32 v216, v249
  v_mov_b32 v217, v249
  v_mov_b32 v218, v249
  v_mov_b32 v219, v249
  v_mov_b32 v220, v249
  v_mov_b32 v221, v249
  v_mov_b32 v222, v249
  v_mov_b32 v223, v249
  v_mov_b32 v224, v249
  v_mov_b32 v225, v249
  v_mov_b32 v226, v249
  v_mov_b32 v227, v249
  v_mov_b32 v228, v249
  v_mov_b32 v229, v249
  v_mov_b32 v230, v249
  v_mov_b32 v231, v249
  s_nop 0
  s_branch P2_zb7
P2_fb:
  ds_read_b128 v[8:11], v253 offset:8192
  ds_read_b128 v[40:43], v253 offset:0
  ds_read_b128 v[12:15], v253 offset:7168
  ds_read_b128 v[16:19], v253 offset:6144
  ds_read_b128 v[20:23], v253 offset:5120
  ds_read_b128 v[24:27], v253 offset:4096
  ds_read_b128 v[28:31], v253 offset:3072
  ds_read_b128 v[32:35], v253 offset:2048
  ds_read_b128 v[36:39], v253 offset:1024
  s_waitcnt lgkmcnt(0)
  v_mov_b32 v216, 0
  v_mov_b32 v217, 0
  v_mov_b32 v218, 0
  v_mov_b32 v219, 0
  v_mov_b32 v220, 0
  v_mov_b32 v221, 0
  v_mov_b32 v222, 0
  v_mov_b32 v223, 0
  v_mov_b32 v224, 0
  v_mov_b32 v225, 0
  v_mov_b32 v226, 0
  v_mov_b32 v227, 0
  v_mov_b32 v228, 0
  v_mov_b32 v229, 0
  v_mov_b32 v230, 0
  v_mov_b32 v231, 0
  s_cmp_eq_u32 s18, 0
  s_cbranch_scc1 P2_of1
P2_zf1:
  v_mfma_f32_32x32x16_bf16 v[80:95], v[12:15], v[44:47], v[216:231]
  s_cmp_eq_u32 s18, 1
  s_cbranch_scc1 P2_of2
P2_zf2:
  v_mfma_f32_32x32x16_bf16 v[96:111], v[16:19], v[44:47], v[216:231]
  s_nop 8
  v_max3_f32 v248, v80, v81, v82
  v_max3_f32 v248, v248, v83, v84
  v_max3_f32 v248, v248, v85, v86
  v_max3_f32 v248, v248, v87, v88
  v_max3_f32 v248, v248, v89, v90
  v_max3_f32 v248, v248, v91, v92
  v_max3_f32 v248, v248, v93, v94
  v_max_f32 v248, v248, v95
  s_cmp_eq_u32 s18, 2
  s_cbranch_scc1 P2_of3
P2_zf3:
  v_mfma_f32_32x32x16_bf16 v[64:79], v[20:23], v[44:47], v[216:231]
  v_max3_f32 v248, v248, v96, v97
  v_max3_f32 v248, v248, v98, v99
  v_max3_f32 v248, v248, v100, v101
  v_max3_f32 v248, v248, v102, v103
  v_max3_f32 v248, v248, v104, v105
  v_max3_f32 v248, v248, v106, v107
  v_max3_f32 v248, v248, v108, v109
  v_max3_f32 v248, v248, v110, v111
  s_cmp_eq_u32 s18, 3
  s_cbranch_scc1 P2_of4
P2_zf4:
  v_mfma_f32_32x32x16_bf16 v[80:95], v[24:27], v[44:47], v[216:231]
  s_nop 0
  v_max3_f32 v248, v248, v64, v65
  v_max3_f32 v248, v248, v66, v67
  v_max3_f32 v248, v248, v68, v69
  v_max3_f32 v248, v248, v70, v71
  v_max3_f32 v248, v248, v72, v73
  v_max3_f32 v248, v248, v74, v75
  v_max3_f32 v248, v248, v76, v77
  v_max3_f32 v248, v248, v78, v79
  s_cmp_eq_u32 s18, 4
  s_cbranch_scc1 P2_of5
P2_zf5:
  v_mfma_f32_32x32x16_bf16 v[96:111], v[28:31], v[44:47], v[216:231]
  v_max3_f32 v248, v248, v80, v81
  v_max3_f32 v248, v248, v82, v83
  v_max3_f32 v248, v248, v84, v85
  v_max3_f32 v248, v248, v86, v87
  v_max3_f32 v248, v248, v88, v89
  v_max3_f32 v248, v248, v90, v91
  v_max3_f32 v248, v248, v92, v93
  v_max3_f32 v248, v248, v94, v95
  s_cmp_eq_u32 s18, 5
  s_cbranch_scc1 P2_of6
P2_zf6:
  v_mfma_f32_32x32x16_bf16 v[64:79], v[32:35], v[44:47], v[216:231]
  s_nop 0
  v_max3_f32 v248, v248, v96, v97
  v_max3_f32 v248, v248, v98, v99
  v_max3_f32 v248, v248, v100, v101
  v_max3_f32 v248, v248, v102, v103
  v_max3_f32 v248, v248, v104, v105
  v_max3_f32 v248, v248, v106, v107
  v_max3_f32 v248, v248, v108, v109
  v_max3_f32 v248, v248, v110, v111
  s_cmp_eq_u32 s18, 6
  s_cbranch_scc1 P2_of7
P2_zf7:
  v_mfma_f32_32x32x16_bf16 v[80:95], v[36:39], v[44:47], v[216:231]
  v_max3_f32 v248, v248, v64, v65
  v_max3_f32 v248, v248, v66, v67
  v_max3_f32 v248, v248, v68, v69
  v_max3_f32 v248, v248, v70, v71
  v_max3_f32 v248, v248, v72, v73
  v_max3_f32 v248, v248, v74, v75
  v_max3_f32 v248, v248, v76, v77
  v_max3_f32 v248, v248, v78, v79
  s_nop 3
  v_max3_f32 v248, v248, v80, v81
  v_max3_f32 v248, v248, v82, v83
  v_max3_f32 v248, v248, v84, v85
  v_max3_f32 v248, v248, v86, v87
  v_max3_f32 v248, v248, v88, v89
  v_max3_f32 v248, v248, v90, v91
  v_max3_f32 v248, v248, v92, v93
  v_max3_f32 v248, v248, v94, v95
  v_mov_b32 v216, s55
  v_mov_b32 v217, s55
  v_mov_b32 v218, s55
  v_mov_b32 v219, s55
  v_mov_b32 v220, s55
  v_mov_b32 v221, s55
  v_mov_b32 v222, s55
  v_mov_b32 v223, s55
  v_mov_b32 v224, s55
  v_mov_b32 v225, s55
  v_mov_b32 v226, s55
  v_mov_b32 v227, s55
  v_mov_b32 v228, s55
  v_mov_b32 v229, s55
  v_mov_b32 v230, s55
  v_mov_b32 v231, s55
  v_mfma_f32_32x32x16_bf16 v[48:63], v[8:11], v[44:47], 0
  s_nop 0
  v_mfma_f32_32x32x16_bf16 v[64:79], v[40:43], v[44:47], v[216:231]
  s_nop 11
  v_cndmask_b32 v48, v64, v48, s[64:65]
  v_cndmask_b32 v49, v65, v49, s[66:67]
  v_cndmask_b32 v50, v66, v50, s[68:69]
  v_cndmask_b32 v51, v67, v51, s[70:71]
  v_cndmask_b32 v52, v68, v52, s[72:73]
  v_cndmask_b32 v53, v69, v53, s[74:75]
  v_cndmask_b32 v54, v70, v54, s[76:77]
  v_cndmask_b32 v55, v71, v55, s[78:79]
  v_cndmask_b32 v56, v72, v56, s[80:81]
  v_cndmask_b32 v57, v73, v57, s[82:83]
  v_cndmask_b32 v58, v74, v58, s[84:85]
  v_cndmask_b32 v59, v75, v59, s[86:87]
  v_cndmask_b32 v60, v76, v60, s[88:89]
  v_cndmask_b32 v61, v77, v61, s[90:91]
  v_cndmask_b32 v62, v78, v62, s[92:93]
  v_cndmask_b32 v63, v79, v63, s[94:95]
  v_max3_f32 v248, v248, v48, v49
  v_max3_f32 v248, v248, v50, v51
  v_max3_f32 v248, v248, v52, v53
  v_max3_f32 v248, v248, v54, v55
  v_max3_f32 v248, v248, v56, v57
  v_max3_f32 v248, v248, v58, v59
  v_max3_f32 v248, v248, v60, v61
  v_max3_f32 v248, v248, v62, v63
  v_mov_b32 v1, v248
  s_nop 1
  v_permlane32_swap_b32 v1, v248
  v_max_f32 v248, v1, v248
  v_pk_add_f32 v[216:217], 0, v[248:249] op_sel:[0,0] op_sel_hi:[1,0] neg_lo:[0,1] neg_hi:[0,1]
  v_pk_add_f32 v[218:219], 0, v[248:249] op_sel:[0,0] op_sel_hi:[1,0] neg_lo:[0,1] neg_hi:[0,1]
  v_pk_add_f32 v[220:221], 0, v[248:249] op_sel:[0,0] op_sel_hi:[1,0] neg_lo:[0,1] neg_hi:[0,1]
  v_pk_add_f32 v[222:223], 0, v[248:249] op_sel:[0,0] op_sel_hi:[1,0] neg_lo:[0,1] neg_hi:[0,1]
  v_pk_add_f32 v[224:225], 0, v[248:249] op_sel:[0,0] op_sel_hi:[1,0] neg_lo:[0,1] neg_hi:[0,1]
  v_pk_add_f32 v[226:227], 0, v[248:249] op_sel:[0,0] op_sel_hi:[1,0] neg_lo:[0,1] neg_hi:[0,1]
  v_pk_add_f32 v[228:229], 0, v[248:249] op_sel:[0,0] op_sel_hi:[1,0] neg_lo:[0,1] neg_hi:[0,1]
  v_pk_add_f32 v[230:231], 0, v[248:249] op_sel:[0,0] op_sel_hi:[1,0] neg_lo:[0,1] neg_hi:[0,1]
  s_cmp_eq_u32 s18, 0
  s_cbranch_scc1 P2_og1
P2_zg1:
  v_mfma_f32_32x32x16_bf16 v[80:95], v[12:15], v[44:47], v[216:231]
  s_cmp_eq_u32 s18, 1
  s_cbranch_scc1 P2_og2
P2_zg2:
  v_mfma_f32_32x32x16_bf16 v[96:111], v[16:19], v[44:47], v[216:231]
  v_pk_add_f32 v[48:49], v[48:49], v[248:249] op_sel:[0,0] op_sel_hi:[1,0] neg_lo:[0,1] neg_hi:[0,1]
  v_pk_add_f32 v[50:51], v[50:51], v[248:249] op_sel:[0,0] op_sel_hi:[1,0] neg_lo:[0,1] neg_hi:[0,1]
  v_pk_add_f32 v[52:53], v[52:53], v[248:249] op_sel:[0,0] op_sel_hi:[1,0] neg_lo:[0,1] neg_hi:[0,1]
  v_pk_add_f32 v[54:55], v[54:55], v[248:249] op_sel:[0,0] op_sel_hi:[1,0] neg_lo:[0,1] neg_hi:[0,1]
  v_pk_add_f32 v[56:57], v[56:57], v[248:249] op_sel:[0,0] op_sel_hi:[1,0] neg_lo:[0,1] neg_hi:[0,1]
  v_pk_add_f32 v[58:59], v[58:59], v[248:249] op_sel:[0,0] op_sel_hi:[1,0] neg_lo:[0,1] neg_hi:[0,1]
  v_pk_add_f32 v[60:61], v[60:61], v[248:249] op_sel:[0,0] op_sel_hi:[1,0] neg_lo:[0,1] neg_hi:[0,1]
  v_pk_add_f32 v[62:63], v[62:63], v[248:249] op_sel:[0,0] op_sel_hi:[1,0] neg_lo:[0,1] neg_hi:[0,1]
  v_exp_f32 v48, v48
  v_exp_f32 v49, v49
  v_exp_f32 v50, v50
  v_exp_f32 v51, v51
  v_exp_f32 v52, v52
  v_exp_f32 v53, v53
  v_exp_f32 v54, v54
  v_exp_f32 v55, v55
  v_exp_f32 v56, v56
  v_exp_f32 v57, v57
  v_exp_f32 v58, v58
  v_exp_f32 v59, v59
  v_exp_f32 v60, v60
  v_exp_f32 v61, v61
  v_exp_f32 v62, v62
  v_exp_f32 v63, v63
  v_cvt_pk_bf16_f32 v136, v48, v49
  v_cvt_pk_bf16_f32 v137, v50, v51
  v_cvt_pk_bf16_f32 v138, v52, v53
  v_cvt_pk_bf16_f32 v139, v54, v55
  v_cvt_pk_bf16_f32 v140, v56, v57
  v_cvt_pk_bf16_f32 v141, v58, v59
  v_cvt_pk_bf16_f32 v142, v60, v61
  v_cvt_pk_bf16_f32 v143, v62, v63
  v_and_b32 v128, v136, v232
  v_and_b32 v129, v137, v233
  v_and_b32 v130, v138, v234
  v_and_b32 v131, v139, v235
  v_and_b32 v132, v140, v236
  v_and_b32 v133, v141, v237
  v_and_b32 v134, v142, v238
  v_and_b32 v135, v143, v239
  v_xor_b32 v136, v136, v128
  v_xor_b32 v137, v137, v129
  v_xor_b32 v138, v138, v130
  v_xor_b32 v139, v139, v131
  v_xor_b32 v140, v140, v132
  v_xor_b32 v141, v141, v133
  v_xor_b32 v142, v142, v134
  v_xor_b32 v143, v143, v135
  v_exp_f32 v80, v80
  v_exp_f32 v81, v81
  v_exp_f32 v82, v82
  v_exp_f32 v83, v83
  v_exp_f32 v84, v84
  v_exp_f32 v85, v85
  v_exp_f32 v86, v86
  v_exp_f32 v87, v87
  v_cvt_pk_bf16_f32 v144, v80, v81
  v_cvt_pk_bf16_f32 v145, v82, v83
  v_cvt_pk_bf16_f32 v146, v84, v85
  v_cvt_pk_bf16_f32 v147, v86, v87
  v_exp_f32 v88, v88
  v_exp_f32 v89, v89
  v_exp_f32 v90, v90
  v_exp_f32 v91, v91
  v_exp_f32 v92, v92
  v_exp_f32 v93, v93
  v_exp_f32 v94, v94
  v_exp_f32 v95, v95
  v_cvt_pk_bf16_f32 v148, v88, v89
  v_cvt_pk_bf16_f32 v149, v90, v91
  v_cvt_pk_bf16_f32 v150, v92, v93
  v_cvt_pk_bf16_f32 v151, v94, v95
  s_cmp_eq_u32 s18, 2
  s_cbranch_scc1 P2_og3
P2_zg3:
  v_mfma_f32_32x32x16_bf16 v[64:79], v[20:23], v[44:47], v[216:231]
  v_exp_f32 v96, v96
  v_exp_f32 v97, v97
  v_exp_f32 v98, v98
  v_exp_f32 v99, v99
  v_exp_f32 v100, v100
  v_exp_f32 v101, v101
  v_exp_f32 v102, v102
  v_exp_f32 v103, v103
  v_cvt_pk_bf16_f32 v152, v96, v97
  v_cvt_pk_bf16_f32 v153, v98, v99
  v_cvt_pk_bf16_f32 v154, v100, v101
  v_cvt_pk_bf16_f32 v155, v102, v103
  v_exp_f32 v104, v104
  v_exp_f32 v105, v105
  v_exp_f32 v106, v106
  v_exp_f32 v107, v107
  v_exp_f32 v108, v108
  v_exp_f32 v109, v109
  v_exp_f32 v110, v110
  v_exp_f32 v111, v111
  v_cvt_pk_bf16_f32 v156, v104, v105
  v_cvt_pk_bf16_f32 v157, v106, v107
  v_cvt_pk_bf16_f32 v158, v108, v109
  v_cvt_pk_bf16_f32 v159, v110, v111
  s_cmp_eq_u32 s18, 3
  s_cbranch_scc1 P2_og4
P2_zg4:
  v_mfma_f32_32x32x16_bf16 v[80:95], v[24:27], v[44:47], v[216:231]
  ds_read_b128 v[8:11], v254 offset:24576
  ds_read_b128 v[12:15], v254 offset:25088
  ds_read_b128 v[16:19], v254 offset:16384
  ds_read_b128 v[20:23], v254 offset:16896
  ds_read_b128 v[48:51], v254 offset:23552
  ds_read_b128 v[52:55], v254 offset:24064
  ds_read_b128 v[56:59], v254 offset:22528
  v_exp_f32 v64, v64
  v_exp_f32 v65, v65
  v_exp_f32 v66, v66
  v_exp_f32 v67, v67
  s_waitcnt lgkmcnt(6)
  v_mfma_f32_32x32x16_bf16 v[112:127], v[8:11], v[128:131], 0
  ds_read_b128 v[60:63], v254 offset:23040
  v_exp_f32 v68, v68
  v_exp_f32 v69, v69
  v_exp_f32 v70, v70
  v_exp_f32 v71, v71
  s_waitcnt lgkmcnt(6)
  v_mfma_f32_32x32x16_bf16 v[112:127], v[12:15], v[132:135], v[112:127]
  ds_read_b128 v[8:11], v254 offset:21504
  v_cvt_pk_bf16_f32 v160, v64, v65
  v_cvt_pk_bf16_f32 v161, v66, v67
  v_cvt_pk_bf16_f32 v162, v68, v69
  v_cvt_pk_bf16_f32 v163, v70, v71
  s_waitcnt lgkmcnt(6)
  v_mfma_f32_32x32x16_bf16 v[112:127], v[16:19], v[136:139], v[112:127]
  ds_read_b128 v[12:15], v254 offset:22016
  v_exp_f32 v72, v72
  v_exp_f32 v73, v73
  v_exp_f32 v74, v74
  v_exp_f32 v75, v75
  s_waitcnt lgkmcnt(6)
  v_mfma_f32_32x32x16_bf16 v[112:127], v[20:23], v[140:143], v[112:127]
  ds_read_b128 v[16:19], v254 offset:20480
  v_exp_f32 v76, v76
  v_exp_f32 v77, v77
  v_exp_f32 v78, v78
  v_exp_f32 v79, v79
  s_waitcnt lgkmcnt(6)
  v_mfma_f32_32x32x16_bf16 v[112:127], v[48:51], v[144:147], v[112:127]
  ds_read_b128 v[20:23], v254 offset:20992
  v_cvt_pk_bf16_f32 v164, v72, v73
  v_cvt_pk_bf16_f32 v165, v74, v75
  v_cvt_pk_bf16_f32 v166, v76, v77
  v_cvt_pk_bf16_f32 v167, v78, v79
  s_cmp_eq_u32 s18, 4
  s_cbranch_scc1 P2_og5
P2_zg5:
  v_mfma_f32_32x32x16_bf16 v[96:111], v[28:31], v[44:47], v[216:231]
  v_exp_f32 v80, v80
  v_exp_f32 v81, v81
  v_exp_f32 v82, v82
  v_exp_f32 v83, v83
  s_waitcnt lgkmcnt(6)
  v_mfma_f32_32x32x16_bf16 v[112:127], v[52:55], v[148:151], v[112:127]
  ds_read_b128 v[48:51], v254 offset:19456
  v_exp_f32 v84, v84
  v_exp_f32 v85, v85
  v_exp_f32 v86, v86
  v_exp_f32 v87, v87
  s_waitcnt lgkmcnt(6)
  v_mfma_f32_32x32x16_bf16 v[112:127], v[56:59], v[152:155], v[112:127]
  ds_read_b128 v[52:55], v254 offset:19968
  v_cvt_pk_bf16_f32 v168, v80, v81
  v_cvt_pk_bf16_f32 v169, v82, v83
  v_cvt_pk_bf16_f32 v170, v84, v85
  v_cvt_pk_bf16_f32 v171, v86, v87
  s_waitcnt lgkmcnt(6)
  v_mfma_f32_32x32x16_bf16 v[112:127], v[60:63], v[156:159], v[112:127]
  ds_read_b128 v[56:59], v254 offset:18432
  v_exp_f32 v88, v88
  v_exp_f32 v89, v89
  v_exp_f32 v90, v90
  v_exp_f32 v91, v91
  s_waitcnt lgkmcnt(6)
  v_mfma_f32_32x32x16_bf16 v[112:127], v[8:11], v[160:163], v[112:127]
  ds_read_b128 v[60:63], v254 offset:18944
  v_exp_f32 v92, v92
  v_exp_f32 v93, v93
  v_exp_f32 v94, v94
  v_exp_f32 v95, v95
  s_waitcnt lgkmcnt(6)
  v_mfma_f32_32x32x16_bf16 v[112:127], v[12:15], v[164:167], v[112:127]
  ds_read_b128 v[8:11], v254 offset:17408
  v_cvt_pk_bf16_f32 v172, v88, v89
  v_cvt_pk_bf16_f32 v173, v90, v91
  v_cvt_pk_bf16_f32 v174, v92, v93
  v_cvt_pk_bf16_f32 v175, v94, v95
  s_cmp_eq_u32 s18, 5
  s_cbranch_scc1 P2_og6
P2_zg6:
  v_mfma_f32_32x32x16_bf16 v[64:79], v[32:35], v[44:47], v[216:231]
  v_exp_f32 v96, v96
  v_exp_f32 v97, v97
  v_exp_f32 v98, v98
  v_exp_f32 v99, v99
  s_waitcnt lgkmcnt(6)
  v_mfma_f32_32x32x16_bf16 v[112:127], v[16:19], v[168:171], v[112:127]
  ds_read_b128 v[12:15], v254 offset:17920
  v_exp_f32 v100, v100
  v_exp_f32 v101, v101
  v_exp_f32 v102, v102
  v_exp_f32 v103, v103
  s_waitcnt lgkmcnt(6)
  v_mfma_f32_32x32x16_bf16 v[112:127], v[20:23], v[172:175], v[112:127]
  v_cvt_pk_bf16_f32 v176, v96, v97
  v_cvt_pk_bf16_f32 v177, v98, v99
  v_cvt_pk_bf16_f32 v178, v100, v101
  v_cvt_pk_bf16_f32 v179, v102, v103
  v_exp_f32 v104, v104
  v_exp_f32 v105, v105
  v_exp_f32 v106, v106
  v_exp_f32 v107, v107
  s_waitcnt lgkmcnt(5)
  v_mfma_f32_32x32x16_bf16 v[112:127], v[48:51], v[176:179], v[112:127]
  v_exp_f32 v108, v108
  v_exp_f32 v109, v109
  v_exp_f32 v110, v110
  v_exp_f32 v111, v111
  v_cvt_pk_bf16_f32 v180, v104, v105
  v_cvt_pk_bf16_f32 v181, v106, v107
  v_cvt_pk_bf16_f32 v182, v108, v109
  v_cvt_pk_bf16_f32 v183, v110, v111
  s_cmp_eq_u32 s18, 6
  s_cbranch_scc1 P2_og7
P2_zg7:
  v_mfma_f32_32x32x16_bf16 v[80:95], v[36:39], v[44:47], v[216:231]
  v_exp_f32 v64, v64
  v_exp_f32 v65, v65
  v_exp_f32 v66, v66
  v_exp_f32 v67, v67
  s_waitcnt lgkmcnt(4)
  v_mfma_f32_32x32x16_bf16 v[112:127], v[52:55], v[180:183], v[112:127]
  v_exp_f32 v68, v68
  v_exp_f32 v69, v69
  v_exp_f32 v70, v70
  v_exp_f32 v71, v71
  v_cvt_pk_bf16_f32 v24, v64, v65
  v_cvt_pk_bf16_f32 v25, v66, v67
  v_cvt_pk_bf16_f32 v26, v68, v69
  v_cvt_pk_bf16_f32 v27, v70, v71
  v_exp_f32 v72, v72
  v_exp_f32 v73, v73
  v_exp_f32 v74, v74
  v_exp_f32 v75, v75
  s_waitcnt lgkmcnt(3)
  v_mfma_f32_32x32x16_bf16 v[112:127], v[56:59], v[24:27], v[112:127]
  v_exp_f32 v76, v76
  v_exp_f32 v77, v77
  v_exp_f32 v78, v78
  v_exp_f32 v79, v79
  v_cvt_pk_bf16_f32 v28, v72, v73
  v_cvt_pk_bf16_f32 v29, v74, v75
  v_cvt_pk_bf16_f32 v30, v76, v77
  v_cvt_pk_bf16_f32 v31, v78, v79
  v_exp_f32 v80, v80
  v_exp_f32 v81, v81
  v_exp_f32 v82, v82
  v_exp_f32 v83, v83
  s_waitcnt lgkmcnt(2)
  v_mfma_f32_32x32x16_bf16 v[112:127], v[60:63], v[28:31], v[112:127]
  v_exp_f32 v84, v84
  v_exp_f32 v85, v85
  v_exp_f32 v86, v86
  v_exp_f32 v87, v87
  v_cvt_pk_bf16_f32 v32, v80, v81
  v_cvt_pk_bf16_f32 v33, v82, v83
  v_cvt_pk_bf16_f32 v34, v84, v85
  v_cvt_pk_bf16_f32 v35, v86, v87
  v_exp_f32 v88, v88
  v_exp_f32 v89, v89
  v_exp_f32 v90, v90
  v_exp_f32 v91, v91
  s_waitcnt lgkmcnt(1)
  v_mfma_f32_32x32x16_bf16 v[112:127], v[8:11], v[32:35], v[112:127]
  v_exp_f32 v92, v92
  v_exp_f32 v93, v93
  v_exp_f32 v94, v94
  v_exp_f32 v95, v95
  v_cvt_pk_bf16_f32 v36, v88, v89
  v_cvt_pk_bf16_f32 v37, v90, v91
  v_cvt_pk_bf16_f32 v38, v92, v93
  v_cvt_pk_bf16_f32 v39, v94, v95
  s_waitcnt lgkmcnt(0)
  s_nop 0
  v_mfma_f32_32x32x16_bf16 v[112:127], v[12:15], v[36:39], v[112:127]
  s_nop 11
  s_branch P2_fbret
P2_of1:
  s_nop 6
  v_mov_b32 v216, v249
  v_mov_b32 v217, v249
  v_mov_b32 v218, v249
  v_mov_b32 v219, v249
  v_mov_b32 v220, v249
  v_mov_b32 v221, v249
  v_mov_b32 v222, v249
  v_mov_b32 v223, v249
  v_mov_b32 v224, v249
  v_mov_b32 v225, v249
  v_mov_b32 v226, v249
  v_mov_b32 v227, v249
  v_mov_b32 v228, v249
  v_mov_b32 v229, v249
  v_mov_b32 v230, v249
  v_mov_b32 v231, v249
  s_nop 0
  s_branch P2_zf1
P2_of2:
  s_nop 6
  v_mov_b32 v216, v249
  v_mov_b32 v217, v249
  v_mov_b32 v218, v249
  v_mov_b32 v219, v249
  v_mov_b32 v220, v249
  v_mov_b32 v221, v249
  v_mov_b32 v222, v249
  v_mov_b32 v223, v249
  v_mov_b32 v224, v249
  v_mov_b32 v225, v249
  v_mov_b32 v226, v249
  v_mov_b32 v227, v249
  v_mov_b32 v228, v249
  v_mov_b32 v229, v249
  v_mov_b32 v230, v249
  v_mov_b32 v231, v249
  s_nop 0
  s_branch P2_zf2
P2_of3:
  s_nop 6
  v_mov_b32 v216, v249
  v_mov_b32 v217, v249
  v_mov_b32 v218, v249
  v_mov_b32 v219, v249
  v_mov_b32 v220, v249
  v_mov_b32 v221, v249
  v_mov_b32 v222, v249
  v_mov_b32 v223, v249
  v_mov_b32 v224, v249
  v_mov_b32 v225, v249
  v_mov_b32 v226, v249
  v_mov_b32 v227, v249
  v_mov_b32 v228, v249
  v_mov_b32 v229, v249
  v_mov_b32 v230, v249
  v_mov_b32 v231, v249
  s_nop 0
  s_branch P2_zf3
P2_of4:
  s_nop 6
  v_mov_b32 v216, v249
  v_mov_b32 v217, v249
  v_mov_b32 v218, v249
  v_mov_b32 v219, v249
  v_mov_b32 v220, v249
  v_mov_b32 v221, v249
  v_mov_b32 v222, v249
  v_mov_b32 v223, v249
  v_mov_b32 v224, v249
  v_mov_b32 v225, v249
  v_mov_b32 v226, v249
  v_mov_b32 v227, v249
  v_mov_b32 v228, v249
  v_mov_b32 v229, v249
  v_mov_b32 v230, v249
  v_mov_b32 v231, v249
  s_nop 0
  s_branch P2_zf4
P2_of5:
  s_nop 6
  v_mov_b32 v216, v249
  v_mov_b32 v217, v249
  v_mov_b32 v218, v249
  v_mov_b32 v219, v249
  v_mov_b32 v220, v249
  v_mov_b32 v221, v249
  v_mov_b32 v222, v249
  v_mov_b32 v223, v249
  v_mov_b32 v224, v249
  v_mov_b32 v225, v249
  v_mov_b32 v226, v249
  v_mov_b32 v227, v249
  v_mov_b32 v228, v249
  v_mov_b32 v229, v249
  v_mov_b32 v230, v249
  v_mov_b32 v231, v249
  s_nop 0
  s_branch P2_zf5
P2_of6:
  s_nop 6
  v_mov_b32 v216, v249
  v_mov_b32 v217, v249
  v_mov_b32 v218, v249
  v_mov_b32 v219, v249
  v_mov_b32 v220, v249
  v_mov_b32 v221, v249
  v_mov_b32 v222, v249
  v_mov_b32 v223, v249
  v_mov_b32 v224, v249
  v_mov_b32 v225, v249
  v_mov_b32 v226, v249
  v_mov_b32 v227, v249
  v_mov_b32 v228, v249
  v_mov_b32 v229, v249
  v_mov_b32 v230, v249
  v_mov_b32 v231, v249
  s_nop 0
  s_branch P2_zf6
P2_of7:
  s_nop 6
  v_mov_b32 v216, v249
  v_mov_b32 v217, v249
  v_mov_b32 v218, v249
  v_mov_b32 v219, v249
  v_mov_b32 v220, v249
  v_mov_b32 v221, v249
  v_mov_b32 v222, v249
  v_mov_b32 v223, v249
  v_mov_b32 v224, v249
  v_mov_b32 v225, v249
  v_mov_b32 v226, v249
  v_mov_b32 v227, v249
  v_mov_b32 v228, v249
  v_mov_b32 v229, v249
  v_mov_b32 v230, v249
  v_mov_b32 v231, v249
  s_nop 0
  s_branch P2_zf7
P2_og1:
  s_nop 6
  v_mov_b32 v216, v249
  v_mov_b32 v217, v249
  v_mov_b32 v218, v249
  v_mov_b32 v219, v249
  v_mov_b32 v220, v249
  v_mov_b32 v221, v249
  v_mov_b32 v222, v249
  v_mov_b32 v223, v249
  v_mov_b32 v224, v249
  v_mov_b32 v225, v249
  v_mov_b32 v226, v249
  v_mov_b32 v227, v249
  v_mov_b32 v228, v249
  v_mov_b32 v229, v249
  v_mov_b32 v230, v249
  v_mov_b32 v231, v249
  s_nop 0
  s_branch P2_zg1
P2_og2:
  s_nop 6
  v_mov_b32 v216, v249
  v_mov_b32 v217, v249
  v_mov_b32 v218, v249
  v_mov_b32 v219, v249
  v_mov_b32 v220, v249
  v_mov_b32 v221, v249
  v_mov_b32 v222, v249
  v_mov_b32 v223, v249
  v_mov_b32 v224, v249
  v_mov_b32 v225, v249
  v_mov_b32 v226, v249
  v_mov_b32 v227, v249
  v_mov_b32 v228, v249
  v_mov_b32 v229, v249
  v_mov_b32 v230, v249
  v_mov_b32 v231, v249
  s_nop 0
  s_branch P2_zg2
P2_og3:
  s_nop 6
  v_mov_b32 v216, v249
  v_mov_b32 v217, v249
  v_mov_b32 v218, v249
  v_mov_b32 v219, v249
  v_mov_b32 v220, v249
  v_mov_b32 v221, v249
  v_mov_b32 v222, v249
  v_mov_b32 v223, v249
  v_mov_b32 v224, v249
  v_mov_b32 v225, v249
  v_mov_b32 v226, v249
  v_mov_b32 v227, v249
  v_mov_b32 v228, v249
  v_mov_b32 v229, v249
  v_mov_b32 v230, v249
  v_mov_b32 v231, v249
  s_nop 0
  s_branch P2_zg3
P2_og4:
  s_nop 6
  v_mov_b32 v216, v249
  v_mov_b32 v217, v249
  v_mov_b32 v218, v249
  v_mov_b32 v219, v249
  v_mov_b32 v220, v249
  v_mov_b32 v221, v249
  v_mov_b32 v222, v249
  v_mov_b32 v223, v249
  v_mov_b32 v224, v249
  v_mov_b32 v225, v249
  v_mov_b32 v226, v249
  v_mov_b32 v227, v249
  v_mov_b32 v228, v249
  v_mov_b32 v229, v249
  v_mov_b32 v230, v249
  v_mov_b32 v231, v249
  s_nop 0
  s_branch P2_zg4
P2_og5:
  s_nop 6
  v_mov_b32 v216, v249
  v_mov_b32 v217, v249
  v_mov_b32 v218, v249
  v_mov_b32 v219, v249
  v_mov_b32 v220, v249
  v_mov_b32 v221, v249
  v_mov_b32 v222, v249
  v_mov_b32 v223, v249
  v_mov_b32 v224, v249
  v_mov_b32 v225, v249
  v_mov_b32 v226, v249
  v_mov_b32 v227, v249
  v_mov_b32 v228, v249
  v_mov_b32 v229, v249
  v_mov_b32 v230, v249
  v_mov_b32 v231, v249
  s_nop 0
  s_branch P2_zg5
P2_og6:
  s_nop 6
  v_mov_b32 v216, v249
  v_mov_b32 v217, v249
  v_mov_b32 v218, v249
  v_mov_b32 v219, v249
  v_mov_b32 v220, v249
  v_mov_b32 v221, v249
  v_mov_b32 v222, v249
  v_mov_b32 v223, v249
  v_mov_b32 v224, v249
  v_mov_b32 v225, v249
  v_mov_b32 v226, v249
  v_mov_b32 v227, v249
  v_mov_b32 v228, v249
  v_mov_b32 v229, v249
  v_mov_b32 v230, v249
  v_mov_b32 v231, v249
  s_nop 0
  s_branch P2_zg6
P2_og7:
  s_nop 6
  v_mov_b32 v216, v249
  v_mov_b32 v217, v249
  v_mov_b32 v218, v249
  v_mov_b32 v219, v249
  v_mov_b32 v220, v249
  v_mov_b32 v221, v249
  v_mov_b32 v222, v249
  v_mov_b32 v223, v249
  v_mov_b32 v224, v249
  v_mov_b32 v225, v249
  v_mov_b32 v226, v249
  v_mov_b32 v227, v249
  v_mov_b32 v228, v249
  v_mov_b32 v229, v249
  v_mov_b32 v230, v249
  v_mov_b32 v231, v249
  s_nop 0
  s_branch P2_zg7
.section .rodata,"a"
.p2align 6
.amdhsa_kernel gated_mix__spectral_fnet__sliding_block__prompt_kernel
  .amdhsa_next_free_vgpr 256
  .amdhsa_next_free_sgpr 102
  .amdhsa_accum_offset 256
  .amdhsa_group_segment_fixed_size 0
  .amdhsa_kernarg_size 96
  .amdhsa_user_sgpr_count 2
  .amdhsa_user_sgpr_kernarg_segment_ptr 1
  .amdhsa_system_sgpr_workgroup_id_x 1
.end_amdhsa_kernel
```
